```python
import torch

def _softmax(x, axis=-1):
    return torch.softmax(x, dim=axis)
def _gelu(x):
    return torch.nn.functional.gelu(x, approximate="tanh")
def _silu(x):
    return torch.nn.functional.silu(x)
def _sigmoid(x):
    return torch.sigmoid(x)
def _layernorm(x, axis=-1, eps=1e-5):
    m = x.mean(dim=axis, keepdim=True)
    v = x.var(dim=axis, keepdim=True, unbiased=False)
    return (x - m) / torch.sqrt(v + eps)
def _scatter_add(tgt, idx, src, axis=0):
    return tgt.clone().index_add_(axis, idx, src)
def _segment_sum(src, seg, n):
    out = torch.zeros((n,) + src.shape[1:], dtype=src.dtype)
    return out.index_add_(0, seg, src)
def _pad(x, pw):
    flat = tuple(v for pair in reversed(pw) for v in pair)
    return torch.nn.functional.pad(x, flat)

kernel_name = 'concat_heads__ssm_conv_s4__mha_block__prompt'

def setup_inputs():

    _w = (lambda a: (lambda t: t.to(torch.bfloat16) if t.is_floating_point() else t)(torch.as_tensor(a)))
    def _A_setup():
        B, L, D, N = 1, 2048, 512, 128
        A_re = -(lambda _x: torch.exp(torch.as_tensor(_x)))((lambda *s: torch.randn(*s, dtype=torch.bfloat16) * 6.4)(D, N))
        A_im = torch.pi * (lambda *s: torch.randn(*s, dtype=torch.bfloat16) * 0.1)(D, N)
        B_re = (lambda *s: torch.randn(*s, dtype=torch.bfloat16) * 0.2)(D, N)
        B_im = (lambda *s: torch.randn(*s, dtype=torch.bfloat16) * 0.2)(D, N)
        C_re = (lambda *s: torch.randn(*s, dtype=torch.bfloat16) * 0.2)(D, N)
        C_im = (lambda *s: torch.randn(*s, dtype=torch.bfloat16) * 0.2)(D, N)
        log_dt = (lambda *s: torch.randn(*s, dtype=torch.bfloat16) * 0.1)(D) * 0.5 - 4.0
        Dskip = (lambda *s: torch.randn(*s, dtype=torch.bfloat16) * 0.1)(D)
        return {
            "u": _w((lambda *s: torch.randn(*s, dtype=torch.bfloat16) * 0.05)(B, L, D)),
            "A_re": _w(A_re),
            "A_im": _w(A_im),
            "B_re": _w(B_re),
            "B_im": _w(B_im),
            "C_re": _w(C_re),
            "C_im": _w(C_im),
            "log_dt": _w(log_dt),
            "Dskip": _w(Dskip),
        }
    _A_in = _A_setup()

    def _B_setup():
        B, S, D, H = 1, 2048, 512, 32
        return {
            "x": _w((lambda *s: torch.randn(*s, dtype=torch.bfloat16) * 0.2)(B, S, D)),
            "wqkv": _w((lambda *s: torch.randn(*s, dtype=torch.bfloat16) * 0.2)(D, 3 * D)),
            "wo": _w((lambda *s: torch.randn(*s, dtype=torch.bfloat16) * 0.05)(D, D)),
        }
    _B_in = _B_setup()

    return {
        "A_u": _A_in["u"],
        "A_A_re": _A_in["A_re"],
        "A_A_im": _A_in["A_im"],
        "A_B_re": _A_in["B_re"],
        "A_B_im": _A_in["B_im"],
        "A_C_re": _A_in["C_re"],
        "A_C_im": _A_in["C_im"],
        "A_log_dt": _A_in["log_dt"],
        "A_Dskip": _A_in["Dskip"],
        "B_x": _B_in["x"],
        "B_wqkv": _B_in["wqkv"],
        "B_wo": _B_in["wo"],
    }

def reference(A_u, A_A_re, A_A_im, A_B_re, A_B_im, A_C_re, A_C_im, A_log_dt, A_Dskip, B_x, B_wqkv, B_wo):
    def _A_ref(u, A_re, A_im, B_re, B_im, C_re, C_im, log_dt, Dskip):
        Bsz, L, D = u.shape
        dt = torch.exp(log_dt)[:, None]
        A = A_re + 1j * A_im
        Bc = B_re + 1j * B_im
        Cc = C_re + 1j * C_im
        logdA = dt * A
        dB = dt * Bc
        l = (lambda x, dt: x.to(dt))(torch.arange(L), A_re.dtype)
        P = torch.exp(logdA[:, :, None] * l[None, None, :])
        K = torch.einsum("dn,dnl,dn->dl", Cc, P, dB).real
        L2 = 2 * L
        Kp = _pad(K, ((0, 0), (0, L)))
        up = (lambda x, *d: x.permute(*d))(u, 0, 2, 1)
        up = _pad(up, ((0, 0), (0, 0), (0, L)))
        Kf = (lambda x, axes=(-2,-1): torch.fft.rfft2(x.float(), dim=axes))(Kp[:, None, :], axes=(-2, -1))
        Uf = (lambda x, axes=(-2,-1): torch.fft.rfft2(x.float(), dim=axes))(up[:, :, None, :], axes=(-2, -1))
        Yf = Uf * Kf[None, :, :, :]
        y = (lambda x, s, axes=(-2,-1): torch.fft.irfft2(x, s=s, dim=axes).to(torch.bfloat16))(Yf, (1, L2), axes=(-2, -1))[:, :, 0, :L]
        y = (lambda x, *d: x.permute(*d))(y, 0, 2, 1) + u * Dskip[None, None, :]
        return y

    def _B_ref(x, wqkv, wo):
        B, S, D = x.shape
        H = 32
        Dh = D // H
        qkv = (lambda x, *d: x.permute(*d))((x @ wqkv).reshape(B, S, 3, H, Dh), 2, 0, 3, 1, 4)
        q, k, v = qkv[0], qkv[1], qkv[2]
        scores = torch.einsum("bhqd,bhkd->bhqk", q, k) * (Dh ** -0.5)
        p = _softmax(scores, axis=-1)
        o = torch.einsum("bhqk,bhkd->bhqd", p, v)
        return (lambda x, *d: x.permute(*d))(o, 0, 2, 1, 3).reshape(B, S, D) @ wo

    a = _A_ref(A_u, A_A_re, A_A_im, A_B_re, A_B_im, A_C_re, A_C_im, A_log_dt, A_Dskip)
    b = _B_ref(B_x, B_wqkv, B_wo)
    return torch.concatenate([a, b], axis=-1)
```

```asm
; @launch kernel=qkv_kgen_kernel grid=(256,1,1) block=(512,1,1) lds=163584
; @launch kernel=attn_conv_kernel grid=(256,1,1) block=(768,1,1) lds=163840
; @launch kernel=concat_heads__ssm_conv_s4__mha_block__prompt_kernel grid=(256,1,1) block=(256,1,1) lds=81920
.amdgcn_target "amdgcn-amd-amdhsa--gfx950"
.text
.globl qkv_kgen_kernel
.p2align 8
.type qkv_kgen_kernel,@function
qkv_kgen_kernel:
    s_cmp_ge_u32 s2, 256
    s_cbranch_scc1 L_k1_end
    v_lshrrev_b32 v7, 6, v0
    v_and_b32 v1, 63, v0
    v_readfirstlane_b32 s44, v7
    s_mov_b32 s3, 64
    s_mov_b32 s63, 64
    s_cmp_ge_u32 s44, 4
    s_cbranch_scc1 L_k1_ld
    s_setprio 3
    s_load_dwordx16 s[16:31], s[0:1], 8
    s_load_dwordx2 s[12:13], s[0:1], 112
    v_mov_b64 v[72:73], 0
    v_mov_b64 v[74:75], 0
    v_mov_b64 v[76:77], 0
    v_mov_b64 v[78:79], 0
    v_mov_b32 v21, 0
    s_lshl_b32 s50, s2, 8
    v_add_lshl_u32 v7, v0, s50, 1
    s_lshr_b32 s52, s44, 1
    s_lshl1_add_u32 s52, s2, s52
    v_lshlrev_b32_e64 v23, 1, s52
    s_waitcnt lgkmcnt(0)
    global_load_short_d16_hi v78, v23, s[28:29]
    global_load_short_d16_hi v72, v7, s[16:17]
    global_load_short_d16_hi v73, v7, s[18:19]
    global_load_short_d16_hi v74, v7, s[20:21]
    global_load_short_d16_hi v75, v7, s[22:23]
    global_load_short_d16_hi v76, v7, s[24:25]
    global_load_short_d16_hi v77, v7, s[26:27]
    s_andn2_b32 exec_lo, 1, s44
    s_mov_b32 exec_hi, 0
    global_load_short_d16_hi v21, v23, s[30:31]
    s_mov_b64 exec, -1
    s_setprio 0
    s_branch L_k1_g0
L_k1_ld:
    s_load_dwordx2 s[4:5], s[0:1], 72
    s_load_dwordx2 s[8:9], s[0:1], 80
    s_bfe_u32 s45, s2, 131073
    s_lshl_b32 s45, s45, 3
    s_bfe_u32 s50, s2, 196611
    s_add_u32 s45, s45, s50
    s_and_b32 s46, s2, 1
    s_lshl_b32 s46, s46, 2
    s_lshr_b32 s51, s2, 6
    s_add_u32 s46, s46, s51
    s_mov_b32 s6, 0x00200000
    s_mov_b32 s7, 0x00020000
    s_mov_b32 s10, 0x00180000
    s_mov_b32 s11, 0x00020000
    s_and_b32 s44, s44, 3
    s_setprio 2
    s_lshl_b32 s51, s51, 1
    s_add_u32 s52, s50, s51
    v_lshrrev_b32 v7, 4, v1
    v_and_b32 v23, 7, v1
    v_xor_b32 v7, v7, v23
    v_lshlrev_b32 v7, 4, v7
    v_lshrrev_b32 v5, 3, v1
    v_lshl_add_u32 v2, v5, 10, v7
    v_xor_b32 v7, 64, v2
    v_add_u32 v3, 7168, v7
    v_bfe_u32 v7, v1, 4, 1
    v_lshlrev_b32 v7, 2, v7
    v_xor_b32 v7, v7, v23
    v_mul_u32_u24 v5, 3072, v5
    v_lshl_add_u32 v4, v7, 4, v5
    s_lshl_b32 s47, s45, 2
    s_add_u32 s47, s47, s44
    s_lshl_b32 s47, s47, 14
    s_mul_i32 s48, s44, 49152
    s_lshl_b32 s50, s46, 7
    s_add_u32 s48, s48, s50
    s_lshl_b32 s49, s44, 13
    s_add_u32 s49, s49, 65280
    s_add_u32 s54, s49, 98304
    s_mov_b32 s53, 0
    s_mov_b64 exec, 0
    s_cmp_eq_u32 s44, 0
    s_cbranch_scc1 L_k1_g2
    s_cmp_eq_u32 s44, 1
    s_cbranch_scc1 L_k1_g3
    s_cmp_eq_u32 s44, 2
    s_cbranch_scc1 L_k1_g4
    s_branch L_k1_g6
L_k1_ld2:
    s_mov_b64 exec, -1
    s_waitcnt lgkmcnt(0)
L_k1_ll:
    s_and_b32 s51, s52, 7
    s_lshl_b32 s50, s51, 7
    s_add_u32 s50, s50, s47
    s_mov_b32 m0, s49
    s_mul_i32 s51, s51, 196608
    buffer_load_dwordx4 v2, s[4:7], s50 offen offset:0 lds
    buffer_load_dwordx4 v3, s[4:7], s50 offen offset:1024 lds
    s_add_u32 m0, s49, 2048
    s_add_u32 s50, s51, s48
    buffer_load_dwordx4 v4, s[8:11], s50 offen offset:0 lds
    buffer_load_dwordx4 v4, s[8:11], s50 offen offset:1024 lds
    buffer_load_dwordx4 v4, s[8:11], s50 offen offset:2048 lds
    s_add_u32 m0, s49, 5120
    s_add_u32 s50, s50, 24576
    buffer_load_dwordx4 v4, s[8:11], s50 offen offset:0 lds
    buffer_load_dwordx4 v4, s[8:11], s50 offen offset:1024 lds
    buffer_load_dwordx4 v4, s[8:11], s50 offen offset:2048 lds
    s_add_u32 s52, s52, 1
    s_add_u32 s49, s49, 32768
    s_cmp_eq_u32 s49, s54
    s_cselect_b32 s50, 98304, 0
    s_sub_u32 s49, s49, s50
    s_add_u32 s53, s53, 1
    s_cmp_lg_u32 s53, 2
    s_cbranch_scc1 L_k1_l1
    s_barrier
L_k1_l1:
    s_cmp_lt_u32 s53, 2
    s_cbranch_scc1 L_k1_ll
    s_cmp_lt_u32 s53, 8
    s_waitcnt vmcnt(8)
    s_barrier
    s_cbranch_scc1 L_k1_ll
    s_waitcnt vmcnt(0)
    s_barrier
L_k1_end:
    s_endpgm
L_k1_g0:
    s_mov_b32 s14, 0x00e00000
    s_mov_b32 s15, 0x00020000
    s_and_b32 s53, s44, 1
    s_mul_i32 s54, s44, 16320
    s_mov_b32 m0, s54
    s_andn2_b32 s50, s44, 1
    s_mul_i32 s54, s50, 16320
    v_lshrrev_b32 v5, 5, v1
    v_lshl_add_u32 v6, v5, 4, s54
    v_and_b32 v7, 31, v1
    v_mul_u32_u24 v23, 272, v7
    v_add_u32 v13, v23, v6
    s_cmp_eq_u32 s53, 1
    s_mov_b32 s60, 0xaf00d500
    s_cselect_b32 s60, 0xa9a95555, s60
    s_mov_b32 s61, 0xafafd5d5
    s_cselect_b32 s61, 0xa9a95555, s61
    s_mov_b32 s62, 0x10113210
    s_cselect_b32 s62, 0x55554444, s62
    s_mov_b32 s63, 0x10117654
    s_cselect_b32 s63, 0x55554444, s63
    s_mov_b32 s64, 0x33332222
    s_cselect_b32 s64, 0x77776666, s64
    s_mov_b32 s65, 0x33332222
    s_cselect_b32 s65, 0x77776666, s65
    s_cselect_b32 s58, 0xaaaaaaaa, 0
    s_mov_b32 s59, s58
    v_and_b32 v23, 15, v1
    v_lshlrev_b32 v23, 2, v23
    v_cmp_lt_u32 vcc, 15, v7
    v_lshrrev_b64 v[64:65], v23, s[62:63]
    v_lshrrev_b64 v[66:67], v23, s[64:65]
    v_lshlrev_b32 v7, 1, v7
    v_cndmask_b32 v64, v64, v66, vcc
    v_lshrrev_b64 v[66:67], v7, s[60:61]
    v_and_b32 v64, 7, v64
    v_and_b32 v66, 3, v66
    v_lshl_add_u32 v64, v66, 3, v64
    v_mul_u32_u24 v64, 272, v64
    v_add_u32 v14, v64, v6
    s_lshl_b32 s50, s52, 12
    s_lshl_b32 s55, s53, 11
    s_add_u32 s55, s55, s50
    s_add_u32 s55, s55, 8388608
    s_lshr_b32 s60, s44, 1
    v_and_b32 v7, 15, v1
    v_bfe_u32 v23, v1, 1, 3
    v_xor_b32 v23, v23, v5
    v_lshlrev_b32 v23, 4, v23
    v_lshl_add_u32 v7, v7, 7, v23
    v_bfe_u32 v23, v1, 4, 1
    v_lshl_add_u32 v7, v23, 13, v7
    s_lshl_b32 s56, s53, 14
    s_add_u32 s56, s56, 65280
    v_xor_b32 v9, 32, v7
    v_xor_b32 v10, 64, v7
    v_xor_b32 v11, 96, v7
    v_add_u32 v8, s56, v7
    v_add_u32 v9, s56, v9
    v_add_u32 v10, s56, v10
    v_add_u32 v11, s56, v11
    v_mul_u32_u24 v7, 3072, v5
    v_bfe_u32 v23, v1, 2, 2
    v_lshl_add_u32 v7, v23, 7, v7
    v_bfe_u32 v23, v1, 3, 1
    v_xor_b32 v23, s60, v23
    v_lshl_add_u32 v7, v23, 6, v7
    v_bfe_u32 v23, v1, 4, 1
    v_lshl_add_u32 v7, v23, 5, v7
    v_and_b32 v23, 1, v1
    v_lshl_add_u32 v7, v23, 4, v7
    v_bfe_u32 v23, v1, 1, 1
    v_lshl_add_u32 v7, v23, 3, v7
    v_add_u32 v12, 67328, v7
    v_lshlrev_b32 v18, 4, v1
    v_lshrrev_b32 v23, 1, v1
    v_xor_b32 v23, v23, v1
    v_bfe_u32 v23, v23, 2, 1
    v_mul_u32_u24 v23, 192, v23
    v_xor_b32 v20, v23, v18
    v_bfe_u32 v23, v1, 4, 1
    v_lshlrev_b32 v23, 17, v23
    v_lshl_add_u32 v23, v5, 9, v23
    v_and_b32 v7, 15, v1
    v_lshl_add_u32 v19, v7, 4, v23
    s_bfe_u32 s45, s2, 131073
    s_lshl_b32 s45, s45, 3
    s_bfe_u32 s50, s2, 196611
    s_add_u32 s45, s45, s50
    s_and_b32 s46, s2, 1
    s_lshl_b32 s46, s46, 2
    s_lshr_b32 s51, s2, 6
    s_add_u32 s46, s46, s51
    s_lshl_b32 s50, s46, 1
    s_add_u32 s50, s50, s60
    s_lshl_b32 s50, s50, 17
    s_lshl_b32 s51, s45, 1
    s_add_u32 s51, s51, s53
    s_lshl_b32 s51, s51, 10
    s_add_u32 s47, s50, s51
    s_add_u32 s48, s47, 65536
    s_lshl_b32 s50, s47, 1
    s_add_u32 s50, s50, 2097152
    s_add_u32 s51, s50, 131072
    v_mov_b64 v[24:25], 0
    v_mov_b64 v[26:27], 0
    v_mov_b64 v[28:29], 0
    v_mov_b64 v[30:31], 0
    v_mov_b64 v[32:33], 0
    v_mov_b64 v[34:35], 0
    v_mov_b64 v[36:37], 0
    v_mov_b64 v[38:39], 0
    v_mov_b64 v[40:41], 0
    v_mov_b64 v[42:43], 0
    v_mov_b64 v[44:45], 0
    v_mov_b64 v[46:47], 0
    v_mov_b64 v[48:49], 0
    v_mov_b64 v[50:51], 0
    v_mov_b64 v[52:53], 0
    v_mov_b64 v[54:55], 0
    v_mov_b64 v[56:57], 0
    v_mov_b64 v[58:59], 0
    v_mov_b64 v[60:61], 0
    v_mov_b64 v[62:63], 0
    v_mov_b64 v[64:65], 0
    v_mov_b64 v[66:67], 0
    v_mov_b64 v[68:69], 0
    v_mov_b64 v[70:71], 0
    v_mov_b64 v[136:137], 0
    v_mov_b64 v[138:139], 0
    v_mov_b64 v[140:141], 0
    v_mov_b64 v[142:143], 0
    v_mov_b64 v[144:145], 0
    v_mov_b64 v[146:147], 0
    v_mov_b64 v[148:149], 0
    v_mov_b64 v[150:151], 0
    v_mov_b64 v[152:153], 0
    v_mov_b64 v[154:155], 0
    v_mov_b64 v[156:157], 0
    v_mov_b64 v[158:159], 0
    v_mov_b64 v[160:161], 0
    v_mov_b64 v[162:163], 0
    v_mov_b64 v[164:165], 0
    v_mov_b64 v[166:167], 0
    v_mov_b64 v[168:169], 0
    v_mov_b64 v[170:171], 0
    v_mov_b64 v[172:173], 0
    v_mov_b64 v[174:175], 0
    v_mov_b64 v[176:177], 0
    v_mov_b64 v[178:179], 0
    v_mov_b64 v[180:181], 0
    v_mov_b64 v[182:183], 0
    s_mov_b32 s61, 0
    s_mov_b32 s63, 0
    s_mov_b32 s3, 0
    s_mov_b32 s54, 32768
L_k1_g2:
    s_mov_b32 s56, 0x3fb8aa3b
    s_mov_b32 s57, 0x32a57060
    v_mov_b32 v102, 1.0
    v_mov_b32 v103, 0
    v_mov_b32 v104, 1.0
    v_mov_b32 v105, 0
    s_waitcnt vmcnt(1)
    v_mul_f32 v120, s56, v78
    v_fma_f32 v121, v78, s56, -v120
    v_exp_f32 v122, v120
    v_fma_f32 v121, v78, s57, v121
    v_mul_f32 v121, 0x3f317218, v121
    v_fma_f32 v122, v122, v121, v122
    v_cvt_pk_bf16_f32 v122, v122, v122
    v_lshlrev_b32 v79, 16, v122
    v_mul_f32 v80, v79, v72
    v_mul_f32 v81, v79, v73
    v_mul_f32 v74, v79, v74
    v_mul_f32 v75, v79, v75
    v_mul_f32 v80, s56, v80
    v_mul_f32 v81, 0x3e22f983, v81
    v_pk_mul_f32 v[122:123], v[76:77], v[74:75] op_sel:[0,0] op_sel_hi:[0,1]
    v_pk_fma_f32 v[94:95], v[76:77], v[74:75], v[122:123] op_sel:[1,1,0] op_sel_hi:[1,0,1] neg_lo:[0,1,0]
    v_ldexp_f32 v110, v80, 6
    v_ldexp_f32 v112, v80, 7
    v_ldexp_f32 v114, v80, 3
    v_ldexp_f32 v116, v80, 8
    v_ldexp_f32 v120, v80, 2
    v_exp_f32 v118, v80
    v_ldexp_f32 v111, v81, 6
    v_ldexp_f32 v113, v81, 7
    v_ldexp_f32 v115, v81, 3
    v_ldexp_f32 v117, v81, 8
    v_ldexp_f32 v121, v81, 2
    v_fract_f32 v119, v81
    v_exp_f32 v110, v110
    v_exp_f32 v112, v112
    v_exp_f32 v114, v114
    v_exp_f32 v116, v116
    v_exp_f32 v120, v120
    v_fract_f32 v111, v111
    v_fract_f32 v113, v113
    v_fract_f32 v115, v115
    v_fract_f32 v117, v117
    v_cos_f32 v84, v119
    v_fract_f32 v121, v121
    v_cos_f32 v90, v111
    v_cos_f32 v108, v113
    v_cos_f32 v88, v115
    v_cos_f32 v92, v117
    v_cos_f32 v86, v121
    v_sin_f32 v85, v119
    v_sin_f32 v91, v111
    v_sin_f32 v109, v113
    v_sin_f32 v89, v115
    v_sin_f32 v93, v117
    v_sin_f32 v87, v121
    v_pk_mul_f32 v[84:85], v[84:85], v[118:119] op_sel:[0,0] op_sel_hi:[1,0]
    v_pk_mul_f32 v[90:91], v[90:91], v[110:111] op_sel:[0,0] op_sel_hi:[1,0]
    v_pk_mul_f32 v[108:109], v[108:109], v[112:113] op_sel:[0,0] op_sel_hi:[1,0]
    v_pk_mul_f32 v[88:89], v[88:89], v[114:115] op_sel:[0,0] op_sel_hi:[1,0]
    v_pk_mul_f32 v[92:93], v[92:93], v[116:117] op_sel:[0,0] op_sel_hi:[1,0]
    v_pk_mul_f32 v[86:87], v[86:87], v[120:121] op_sel:[0,0] op_sel_hi:[1,0]
    v_pk_mul_f32 v[110:111], v[94:95], v[90:91] op_sel:[0,0] op_sel_hi:[0,1]
    v_pk_mul_f32 v[112:113], v[94:95], v[108:109] op_sel:[0,0] op_sel_hi:[0,1]
    v_pk_fma_f32 v[96:97], v[94:95], v[90:91], v[110:111] op_sel:[1,1,0] op_sel_hi:[1,0,1] neg_lo:[0,1,0]
    v_pk_fma_f32 v[98:99], v[94:95], v[108:109], v[112:113] op_sel:[1,1,0] op_sel_hi:[1,0,1] neg_lo:[0,1,0]
    v_pk_mul_f32 v[110:111], v[98:99], v[90:91] op_sel:[0,0] op_sel_hi:[0,1]
    v_pk_fma_f32 v[100:101], v[98:99], v[90:91], v[110:111] op_sel:[1,1,0] op_sel_hi:[1,0,1] neg_lo:[0,1,0]
    s_cbranch_execz L_k1_ld2
L_k1_g3:
L_k1_m:
    s_cmp_gt_u32 s3, 3
    s_cbranch_scc1 L_k1_m2
    v_pk_mul_f32 v[122:123], v[104:105], v[86:87] op_sel:[0,0] op_sel_hi:[0,1]
    v_pk_fma_f32 v[108:109], v[104:105], v[86:87], v[122:123] op_sel:[1,1,0] op_sel_hi:[1,0,1] neg_lo:[0,1,0]
    v_cvt_pk_bf16_f32 v133, v108, -v109
    ds_write_addtid_b32 v133 offset:15232
L_k1_m2:
    v_pk_mul_f32 v[120:121], v[104:105], v[88:89] op_sel:[0,0] op_sel_hi:[0,1]
    v_cvt_pk_bf16_f32 v126, v94, v95
    v_cvt_pk_bf16_f32 v127, v96, v97
    v_cvt_pk_bf16_f32 v128, v98, v99
    v_cvt_pk_bf16_f32 v129, v100, v101
    v_cvt_pk_bf16_f32 v130, v102, -v103
    v_pk_fma_f32 v[106:107], v[104:105], v[88:89], v[120:121] op_sel:[1,1,0] op_sel_hi:[1,0,1] neg_lo:[0,1,0]
    ds_write_addtid_b32 v126 offset:0
    ds_write_addtid_b32 v127 offset:2176
    ds_write_addtid_b32 v128 offset:4352
    ds_write_addtid_b32 v129 offset:6528
    ds_write_addtid_b32 v130 offset:8704
    v_cvt_pk_bf16_f32 v131, v104, -v105
    ds_write_addtid_b32 v131 offset:10880
    v_pk_mul_f32 v[110:111], v[94:95], v[88:89] op_sel:[0,0] op_sel_hi:[0,1]
    v_pk_mul_f32 v[112:113], v[96:97], v[88:89] op_sel:[0,0] op_sel_hi:[0,1]
    v_pk_mul_f32 v[114:115], v[98:99], v[88:89] op_sel:[0,0] op_sel_hi:[0,1]
    v_pk_mul_f32 v[116:117], v[100:101], v[88:89] op_sel:[0,0] op_sel_hi:[0,1]
    v_pk_mul_f32 v[118:119], v[102:103], v[84:85] op_sel:[0,0] op_sel_hi:[0,1]
    v_cvt_pk_bf16_f32 v132, v106, -v107
    v_pk_fma_f32 v[94:95], v[94:95], v[88:89], v[110:111] op_sel:[1,1,0] op_sel_hi:[1,0,1] neg_lo:[0,1,0]
    v_pk_fma_f32 v[96:97], v[96:97], v[88:89], v[112:113] op_sel:[1,1,0] op_sel_hi:[1,0,1] neg_lo:[0,1,0]
    v_pk_fma_f32 v[98:99], v[98:99], v[88:89], v[114:115] op_sel:[1,1,0] op_sel_hi:[1,0,1] neg_lo:[0,1,0]
    v_pk_fma_f32 v[100:101], v[100:101], v[88:89], v[116:117] op_sel:[1,1,0] op_sel_hi:[1,0,1] neg_lo:[0,1,0]
    v_pk_fma_f32 v[102:103], v[102:103], v[84:85], v[118:119] op_sel:[1,1,0] op_sel_hi:[1,0,1] neg_lo:[0,1,0]
    ds_write_addtid_b32 v132 offset:13056
    s_add_u32 s3, s3, 1
    v_pk_mul_f32 v[124:125], v[104:105], v[92:93] op_sel:[0,0] op_sel_hi:[0,1]
    s_add_u32 m0, m0, 272
    s_cmp_lt_u32 s3, 8
    v_pk_fma_f32 v[104:105], v[104:105], v[92:93], v[124:125] op_sel:[1,1,0] op_sel_hi:[1,0,1] neg_lo:[0,1,0]
    s_cbranch_scc1 L_k1_m
    s_sub_u32 m0, m0, 2176
    v_pk_mul_f32 v[110:111], v[84:85], v[84:85] op_sel:[0,0] op_sel_hi:[0,1]
    v_pk_mul_f32 v[112:113], v[92:93], v[86:87] op_sel:[0,0] op_sel_hi:[0,1]
    v_pk_fma_f32 v[102:103], v[84:85], v[84:85], v[110:111] op_sel:[1,1,0] op_sel_hi:[1,0,1] neg_lo:[0,1,0]
    v_pk_fma_f32 v[108:109], v[92:93], v[86:87], v[112:113] op_sel:[1,1,0] op_sel_hi:[1,0,1] neg_lo:[0,1,0]
    v_pk_mul_f32 v[110:111], v[92:93], v[102:103] op_sel:[0,0] op_sel_hi:[0,1]
    v_pk_mul_f32 v[112:113], v[108:109], v[102:103] op_sel:[0,0] op_sel_hi:[0,1]
    v_pk_fma_f32 v[106:107], v[92:93], v[102:103], v[110:111] op_sel:[1,1,0] op_sel_hi:[1,0,1] neg_lo:[0,1,0]
    v_pk_fma_f32 v[104:105], v[108:109], v[102:103], v[112:113] op_sel:[1,1,0] op_sel_hi:[1,0,1] neg_lo:[0,1,0]
    v_cvt_pk_bf16_f32 v126, v106, -v107
    v_cvt_pk_bf16_f32 v127, v104, -v105
    ds_write_addtid_b32 v126 offset:10880
    ds_write_addtid_b32 v127 offset:13056
    s_mov_b32 s56, 0x3eb8aa3b
    s_mov_b32 s57, 0x3eb8aa3b
    s_cbranch_execz L_k1_ld2
    s_waitcnt vmcnt(0) lgkmcnt(0)
    s_barrier
L_k1_g4:
    ds_read_b128 v[72:75], v14 offset:8704
    ds_read_b128 v[76:79], v13 offset:0
    ds_read_b128 v[80:83], v14 offset:25024
    ds_read_b128 v[84:87], v13 offset:16320
    ds_read_b128 v[88:91], v14 offset:8736
    ds_read_b128 v[92:95], v13 offset:32
    ds_read_b128 v[96:99], v14 offset:25056
    ds_read_b128 v[100:103], v13 offset:16352
L_k1_p:
    ds_read_b128 v[104:107], v14 offset:8768
    ds_read_b128 v[108:111], v13 offset:64
    s_waitcnt lgkmcnt(8)
    v_mfma_f32_32x32x16_bf16 v[136:151], v[72:75], v[76:79], v[136:151]
    ds_read_b128 v[112:115], v14 offset:25088
    ds_read_b128 v[116:119], v13 offset:16384
    s_waitcnt lgkmcnt(8)
    v_mfma_f32_32x32x16_bf16 v[136:151], v[80:83], v[84:87], v[136:151]
    ds_read_b128 v[120:123], v14 offset:8800
    ds_read_b128 v[124:127], v13 offset:96
    s_waitcnt lgkmcnt(8)
    v_mfma_f32_32x32x16_bf16 v[136:151], v[88:91], v[92:95], v[136:151]
    ds_read_b128 v[128:131], v14 offset:25120
    ds_read_b128 v[132:135], v13 offset:16416
    s_waitcnt lgkmcnt(8)
    v_mfma_f32_32x32x16_bf16 v[136:151], v[96:99], v[100:103], v[136:151]
    v_add_u32 v14, 128, v14
    v_add_u32 v13, 128, v13
    s_add_u32 s3, s3, 1
    s_cmp_lt_u32 s3, 10
    ds_read_b128 v[72:75], v14 offset:8704
    ds_read_b128 v[76:79], v13 offset:0
    s_waitcnt lgkmcnt(8)
    v_mfma_f32_32x32x16_bf16 v[136:151], v[104:107], v[108:111], v[136:151]
    ds_read_b128 v[80:83], v14 offset:25024
    ds_read_b128 v[84:87], v13 offset:16320
    s_waitcnt lgkmcnt(8)
    v_mfma_f32_32x32x16_bf16 v[136:151], v[112:115], v[116:119], v[136:151]
    ds_read_b128 v[88:91], v14 offset:8736
    ds_read_b128 v[92:95], v13 offset:32
    s_waitcnt lgkmcnt(8)
    v_mfma_f32_32x32x16_bf16 v[136:151], v[120:123], v[124:127], v[136:151]
    ds_read_b128 v[96:99], v14 offset:25056
    ds_read_b128 v[100:103], v13 offset:16352
    s_waitcnt lgkmcnt(8)
    v_mfma_f32_32x32x16_bf16 v[136:151], v[128:131], v[132:135], v[136:151]
    s_cbranch_scc1 L_k1_p
    s_nop 10
    v_add_f32 v136, v136, v21
    v_cndmask_b32 v140, v140, v141, s[58:59]
    v_cndmask_b32 v148, v148, v149, s[58:59]
    v_cvt_pk_bf16_f32 v104, v136, v137
    v_cvt_pk_bf16_f32 v105, v138, v139
    v_cvt_pk_bf16_f32 v106, v140, v141
    v_cvt_pk_bf16_f32 v107, v142, v143
    v_cvt_pk_bf16_f32 v108, v144, v145
    v_cvt_pk_bf16_f32 v109, v146, v147
    v_cvt_pk_bf16_f32 v110, v148, v149
    v_cvt_pk_bf16_f32 v111, v150, v151
    s_cbranch_execz L_k1_ld2
    buffer_store_dwordx4 v[104:107], v18, s[12:15], s55 offen sc1
    buffer_store_dwordx4 v[108:111], v18, s[12:15], s55 offen offset:1024 sc1
L_k1_loop:
    s_waitcnt lgkmcnt(0)
    s_barrier
L_k1_g6:
    ds_read_b128 v[72:75], v8
    ds_read_b64_tr_b16 v[76:77], v12 offset:0
    v_mfma_f32_32x32x16_bf16 v[24:39], v[156:159], v[152:155], v[24:39]
    ds_read_b64_tr_b16 v[78:79], v12 offset:512
    ds_read_b64_tr_b16 v[80:81], v12 offset:1024
    ds_read_b64_tr_b16 v[82:83], v12 offset:1536
    v_mfma_f32_32x32x16_bf16 v[40:55], v[160:163], v[152:155], v[40:55]
    ds_read_b64_tr_b16 v[84:85], v12 offset:2048
    ds_read_b64_tr_b16 v[86:87], v12 offset:2560
    ds_read_b128 v[88:91], v9
    v_mfma_f32_32x32x16_bf16 v[56:71], v[152:155], v[164:167], v[56:71]
    ds_read_b64_tr_b16 v[92:93], v12 offset:8192
    ds_read_b64_tr_b16 v[94:95], v12 offset:8704
    ds_read_b64_tr_b16 v[96:97], v12 offset:9216
    v_mfma_f32_32x32x16_bf16 v[24:39], v[172:175], v[168:171], v[24:39]
    ds_read_b64_tr_b16 v[98:99], v12 offset:9728
    ds_read_b64_tr_b16 v[100:101], v12 offset:10240
    ds_read_b64_tr_b16 v[102:103], v12 offset:10752
    v_mfma_f32_32x32x16_bf16 v[40:55], v[176:179], v[168:171], v[40:55]
    ds_read_b128 v[152:155], v10
    ds_read_b64_tr_b16 v[156:157], v12 offset:16384
    ds_read_b64_tr_b16 v[158:159], v12 offset:16896
    v_mfma_f32_32x32x16_bf16 v[56:71], v[168:171], v[180:183], v[56:71]
    ds_read_b64_tr_b16 v[160:161], v12 offset:17408
    ds_read_b64_tr_b16 v[162:163], v12 offset:17920
    ds_read_b64_tr_b16 v[164:165], v12 offset:18432
    s_waitcnt lgkmcnt(13)
    v_mfma_f32_32x32x16_bf16 v[24:39], v[76:79], v[72:75], v[24:39]
    ds_read_b64_tr_b16 v[166:167], v12 offset:18944
    ds_read_b128 v[168:171], v11
    ds_read_b64_tr_b16 v[172:173], v12 offset:24576
    v_mfma_f32_32x32x16_bf16 v[40:55], v[80:83], v[72:75], v[40:55]
    ds_read_b64_tr_b16 v[174:175], v12 offset:25088
    ds_read_b64_tr_b16 v[176:177], v12 offset:25600
    ds_read_b64_tr_b16 v[178:179], v12 offset:26112
    v_mfma_f32_32x32x16_bf16 v[56:71], v[72:75], v[84:87], v[56:71]
    ds_read_b64_tr_b16 v[180:181], v12 offset:26624
    ds_read_b64_tr_b16 v[182:183], v12 offset:27136
    s_waitcnt lgkmcnt(14)
    v_mfma_f32_32x32x16_bf16 v[24:39], v[92:95], v[88:91], v[24:39]
    s_add_u32 s61, s61, 1
    s_cmp_eq_u32 s61, 3
    s_cselect_b32 s61, 0, s61
    s_cselect_b32 s62, 0xffff0000, s54
    v_add_u32 v8, s62, v8
    v_mfma_f32_32x32x16_bf16 v[40:55], v[96:99], v[88:91], v[40:55]
    v_add_u32 v9, s62, v9
    v_add_u32 v10, s62, v10
    v_add_u32 v11, s62, v11
    v_add_u32 v12, s62, v12
    s_add_u32 s63, s63, 1
    s_cmp_lt_u32 s63, 8
    v_mfma_f32_32x32x16_bf16 v[56:71], v[88:91], v[100:103], v[56:71]
    s_cbranch_scc1 L_k1_loop
    s_cbranch_execz L_k1_t0
    s_waitcnt lgkmcnt(0)
L_k1_t0:
    v_mfma_f32_32x32x16_bf16 v[24:39], v[156:159], v[152:155], v[24:39]
    v_mfma_f32_32x32x16_bf16 v[24:39], v[172:175], v[168:171], v[24:39]
    v_mfma_f32_32x32x16_bf16 v[40:55], v[160:163], v[152:155], v[40:55]
    v_mfma_f32_32x32x16_bf16 v[40:55], v[176:179], v[168:171], v[40:55]
    v_mfma_f32_32x32x16_bf16 v[56:71], v[152:155], v[164:167], v[56:71]
    s_nop 8
    v_pk_mul_f32 v[24:25], v[24:25], s[56:57]
    v_pk_mul_f32 v[26:27], v[26:27], s[56:57]
    v_pk_mul_f32 v[28:29], v[28:29], s[56:57]
    v_pk_mul_f32 v[30:31], v[30:31], s[56:57]
    v_pk_mul_f32 v[32:33], v[32:33], s[56:57]
    v_pk_mul_f32 v[34:35], v[34:35], s[56:57]
    v_mfma_f32_32x32x16_bf16 v[56:71], v[168:171], v[180:183], v[56:71]
    v_pk_mul_f32 v[36:37], v[36:37], s[56:57]
    v_pk_mul_f32 v[38:39], v[38:39], s[56:57]
    v_cvt_pk_bf16_f32 v72, v24, v25
    v_cvt_pk_bf16_f32 v73, v26, v27
    v_cvt_pk_bf16_f32 v74, v28, v29
    v_cvt_pk_bf16_f32 v75, v30, v31
    v_cvt_pk_bf16_f32 v76, v32, v33
    v_cvt_pk_bf16_f32 v77, v34, v35
    v_cvt_pk_bf16_f32 v78, v36, v37
    v_cvt_pk_bf16_f32 v79, v38, v39
    s_cbranch_execz L_k1_t1
    buffer_store_dwordx4 v[72:75], v18, s[12:15], s47 offen sc1
    buffer_store_dwordx4 v[76:79], v18, s[12:15], s48 offen sc1
L_k1_t1:
    v_cvt_pk_bf16_f32 v80, v40, v41
    v_cvt_pk_bf16_f32 v81, v42, v43
    v_cvt_pk_bf16_f32 v82, v44, v45
    v_cvt_pk_bf16_f32 v83, v46, v47
    v_cvt_pk_bf16_f32 v84, v48, v49
    v_cvt_pk_bf16_f32 v85, v50, v51
    v_cvt_pk_bf16_f32 v86, v52, v53
    v_cvt_pk_bf16_f32 v87, v54, v55
    s_cbranch_execz L_k1_t2
    buffer_store_dwordx4 v[80:83], v20, s[12:15], s50 offen sc1
    buffer_store_dwordx4 v[84:87], v20, s[12:15], s51 offen sc1
L_k1_t2:
    v_cvt_pk_bf16_f32 v88, v56, v57
    v_cvt_pk_bf16_f32 v89, v58, v59
    v_cvt_pk_bf16_f32 v90, v60, v61
    v_cvt_pk_bf16_f32 v91, v62, v63
    v_cvt_pk_bf16_f32 v92, v64, v65
    v_cvt_pk_bf16_f32 v93, v66, v67
    v_cvt_pk_bf16_f32 v94, v68, v69
    v_cvt_pk_bf16_f32 v95, v70, v71
    s_cbranch_execz L_k1_ld2
    buffer_store_dwordx4 v[88:91], v19, s[12:15], s50 offen offset:1024 sc1
    buffer_store_dwordx4 v[92:95], v19, s[12:15], s50 offen offset:1280 sc1
    s_endpgm
.globl attn_conv_kernel
.p2align 8
.type attn_conv_kernel,@function
attn_conv_kernel:
    s_cmp_ge_u32 s2, 256
    s_cbranch_scc1 L_k2_end
    s_load_dwordx2 s[4:5], s[0:1], 112
    s_load_dwordx2 s[8:9], s[0:1], 0
    s_load_dwordx2 s[40:41], s[0:1], 88
    v_lshrrev_b32 v3, 6, v0
    v_and_b32 v1, 63, v0
    v_readfirstlane_b32 s16, v3
    v_lshlrev_b32 v2, 4, v1
    s_mov_b32 s6, 0x00e00000
    s_mov_b32 s7, 0x00020000
    s_and_b32 s19, s2, 7
    s_lshr_b32 s20, s2, 3
    s_lshl_b32 s17, s19, 2
    s_and_b32 s18, s20, 3
    s_add_u32 s17, s17, s18
    s_lshr_b32 s18, s20, 2
    s_lshl_b32 s32, s17, 17
    s_add_u32 s32, s32, 2097152
    s_cmp_ge_u32 s16, 8
    s_cbranch_scc1 L_k2_conv
    s_lshl_b32 s18, s18, 3
    s_add_u32 s18, s18, s16
    s_lshl_b32 s19, s17, 16
    s_lshl_b32 s20, s18, 10
    s_add_u32 s19, s19, s20
    s_lshl_b32 s33, s16, 13
    s_add_u32 s34, s32, s33
    s_add_u32 s35, s34, 4096
    s_mov_b32 m0, s33
    s_waitcnt lgkmcnt(0)
    buffer_load_dwordx4 v[4:7], v2, s[4:7], s19 offen
    buffer_load_dwordx4 v2, s[4:7], s34 offen offset:0 lds
    buffer_load_dwordx4 v2, s[4:7], s34 offen offset:1024 lds
    buffer_load_dwordx4 v2, s[4:7], s34 offen offset:2048 lds
    buffer_load_dwordx4 v2, s[4:7], s34 offen offset:3072 lds
    s_add_u32 m0, s33, 4096
    s_nop 0
    buffer_load_dwordx4 v2, s[4:7], s35 offen offset:0 lds
    buffer_load_dwordx4 v2, s[4:7], s35 offen offset:1024 lds
    buffer_load_dwordx4 v2, s[4:7], s35 offen offset:2048 lds
    buffer_load_dwordx4 v2, s[4:7], s35 offen offset:3072 lds
    s_mov_b32 s26, 0x0000ffff
    s_mov_b32 s27, 0x0000ffff
    v_and_b32 v106, 27, v1
    v_cmp_eq_u32 vcc, 16, v106
    v_mov_b32 v106, 0x3f803f80
    s_nop 0
    v_cndmask_b32 v106, 0, v106, vcc
    v_mov_b32 v88, v106
    v_mov_b32 v89, v106
    v_mov_b32 v90, v106
    v_mov_b32 v91, v106
    v_mov_b32 v92, v106
    v_mov_b32 v93, v106
    v_mov_b32 v94, v106
    v_mov_b32 v95, v106
    v_mov_b32 v96, v106
    v_mov_b32 v97, v106
    v_mov_b32 v98, v106
    v_mov_b32 v99, v106
    v_mov_b32 v100, v106
    v_mov_b32 v101, v106
    v_mov_b32 v102, v106
    v_mov_b32 v103, v106
    v_mov_b32 v107, 0x1ffff
    s_cmp_lt_u32 s16, 4
    s_movk_i32 s36, 8192
    s_cselect_b32 s36, s36, -8192
    s_cbranch_scc1 L_k2_old
    s_setprio 1
L_k2_old:
    s_mul_i32 s38, s36, 12
    s_add_u32 s38, s38, s33
    s_lshl_b32 s39, s36, 4
    s_add_u32 s39, s39, s33
    v_mov_b32 v64, 0
    v_mov_b32 v65, 0
    v_mov_b32 v66, 0
    v_mov_b32 v67, 0
    v_mov_b32 v68, 0
    v_mov_b32 v69, 0
    v_mov_b32 v70, 0
    v_mov_b32 v71, 0
    v_mov_b32 v72, 0
    v_mov_b32 v73, 0
    v_mov_b32 v74, 0
    v_mov_b32 v75, 0
    v_mov_b32 v76, 0
    v_mov_b32 v77, 0
    v_mov_b32 v78, 0
    v_mov_b32 v79, 0
    v_mov_b64 v[48:49], 0
    v_mov_b64 v[50:51], 0
    v_mov_b64 v[52:53], 0
    v_mov_b64 v[54:55], 0
    v_mov_b32 v56, 0xdddddddd
    v_add_u32 v104, s33, v2
    s_mov_b32 s22, s33
    s_lshl_b32 s37, s36, 2
    s_add_u32 s37, s37, s33
    s_mov_b64 vcc, 0
    s_waitcnt vmcnt(4)
    ds_read_b128 v[80:83], v104
    ds_read_b128 v[84:87], v104 offset:2048
    s_mov_b64 exec, s[26:27]
    ds_read_b128 v[88:91], v104 offset:1024
    ds_read_b128 v[92:95], v104 offset:1280
    s_mov_b64 exec, -1
    s_waitcnt lgkmcnt(3)
    v_mfma_f32_32x32x16_bf16 v[24:39], v[80:83], v[4:7], 0
    s_waitcnt vmcnt(0)
    s_waitcnt lgkmcnt(0)
    s_nop 7
    s_nop 3
    .p2align 6
L_k2_loopa:
    v_exp_f32 v24, v24
    v_exp_f32 v25, v25
    v_exp_f32_e64 v26, v26
    v_smfmac_f32_32x32x32_bf16 v[64:79], v[100:103], v[48:55], v56
    s_add_u32 s22, s22, s36
    v_exp_f32 v27, v27
    v_exp_f32_e64 v28, v28
    s_waitcnt lgkmcnt(0)
    s_mov_b64 exec, s[26:27]
    ds_read_b128 v[96:99], v104 offset:3072
    ds_read_b128 v[100:103], v104 offset:3328
    s_mov_b64 exec, -1
    s_nop 0
    v_mfma_f32_32x32x16_bf16 v[40:55], v[84:87], v[4:7], 0
    ds_read_b128 v[80:83], v104 offset:4096
    v_exp_f32 v29, v29
    v_exp_f32 v30, v30
    v_exp_f32 v31, v31
    v_exp_f32 v32, v32
    v_exp_f32 v33, v33
    v_exp_f32 v34, v34
    v_smfmac_f32_32x32x32_bf16 v[64:79], v[88:91], v[24:31], v56
    v_exp_f32 v35, v35
    v_exp_f32 v36, v36
    v_exp_f32 v37, v37
    v_exp_f32 v38, v38
    v_exp_f32 v39, v39
    v_exp_f32 v40, v40
    v_exp_f32 v41, v41
    v_exp_f32 v42, v42
    v_smfmac_f32_32x32x32_bf16 v[64:79], v[92:95], v[32:39], v56
    v_and_or_b32 v105, s22, v107, v2
    v_exp_f32 v43, v43
    v_exp_f32 v44, v44
    s_waitcnt lgkmcnt(0)
    s_mov_b64 exec, s[26:27]
    ds_read_b128 v[88:91], v104 offset:5120
    ds_read_b128 v[92:95], v104 offset:5376
    s_mov_b64 exec, -1
    s_nop 0
    v_mfma_f32_32x32x16_bf16 v[24:39], v[80:83], v[4:7], 0
    ds_read_b128 v[84:87], v104 offset:6144
    v_exp_f32 v45, v45
    v_exp_f32 v46, v46
    v_exp_f32 v47, v47
    v_exp_f32 v48, v48
    v_exp_f32 v49, v49
    v_exp_f32 v50, v50
    v_smfmac_f32_32x32x32_bf16 v[64:79], v[96:99], v[40:47], v56
    v_exp_f32 v51, v51
    v_exp_f32 v52, v52
    v_exp_f32 v53, v53
    v_exp_f32 v54, v54
    v_exp_f32 v55, v55
    v_exp_f32 v24, v24
    v_exp_f32 v25, v25
    v_exp_f32 v26, v26
    v_smfmac_f32_32x32x32_bf16 v[64:79], v[100:103], v[48:55], v56
    s_cbranch_vccz L_k2_bar
L_k2_barx:
    v_exp_f32 v27, v27
    v_exp_f32_e64 v28, v28
    s_waitcnt lgkmcnt(0)
    s_mov_b64 exec, s[26:27]
    ds_read_b128 v[96:99], v104 offset:7168
    ds_read_b128 v[100:103], v104 offset:7424
    s_mov_b64 exec, -1
    s_nop 0
    v_mfma_f32_32x32x16_bf16 v[40:55], v[84:87], v[4:7], 0
    ds_read_b128 v[80:83], v105 offset:0
    v_exp_f32 v29, v29
    v_exp_f32 v30, v30
    v_exp_f32 v31, v31
    v_exp_f32 v32, v32
    v_exp_f32 v33, v33
    v_exp_f32 v34, v34
    v_smfmac_f32_32x32x32_bf16 v[64:79], v[88:91], v[24:31], v56
    v_exp_f32 v35, v35
    v_exp_f32 v36, v36
    v_exp_f32 v37, v37
    v_exp_f32 v38, v38
    v_exp_f32 v39, v39
    v_exp_f32 v40, v40
    v_exp_f32 v41, v41
    v_exp_f32 v42, v42
    v_smfmac_f32_32x32x32_bf16 v[64:79], v[92:95], v[32:39], v56
    v_exp_f32 v43, v43
    v_exp_f32 v44, v44
    s_waitcnt lgkmcnt(0)
    s_mov_b64 exec, s[26:27]
    ds_read_b128 v[88:91], v105 offset:1024
    ds_read_b128 v[92:95], v105 offset:1280
    s_mov_b64 exec, -1
    s_nop 0
    v_mfma_f32_32x32x16_bf16 v[24:39], v[80:83], v[4:7], 0
    ds_read_b128 v[84:87], v105 offset:2048
    v_exp_f32 v45, v45
    v_exp_f32 v46, v46
    v_exp_f32 v47, v47
    v_exp_f32 v48, v48
    v_exp_f32 v49, v49
    v_exp_f32 v50, v50
    v_smfmac_f32_32x32x32_bf16 v[64:79], v[96:99], v[40:47], v56
    v_exp_f32 v51, v51
    v_exp_f32 v52, v52
    v_exp_f32 v53, v53
    v_exp_f32 v54, v54
    v_exp_f32 v55, v55
    v_exp_f32 v24, v24
    v_exp_f32 v25, v25
    v_exp_f32 v26, v26
    v_smfmac_f32_32x32x32_bf16 v[64:79], v[100:103], v[48:55], v56
    s_add_u32 s22, s22, s36
    v_exp_f32 v27, v27
    v_exp_f32_e64 v28, v28
    s_waitcnt lgkmcnt(0)
    s_mov_b64 exec, s[26:27]
    ds_read_b128 v[96:99], v105 offset:3072
    ds_read_b128 v[100:103], v105 offset:3328
    s_mov_b64 exec, -1
    s_nop 0
    v_mfma_f32_32x32x16_bf16 v[40:55], v[84:87], v[4:7], 0
    ds_read_b128 v[80:83], v105 offset:4096
    v_exp_f32 v29, v29
    v_exp_f32 v30, v30
    v_exp_f32 v31, v31
    v_exp_f32 v32, v32
    v_exp_f32 v33, v33
    v_exp_f32 v34, v34
    v_smfmac_f32_32x32x32_bf16 v[64:79], v[88:91], v[24:31], v56
    v_exp_f32 v35, v35
    v_exp_f32 v36, v36
    v_exp_f32 v37, v37
    v_exp_f32 v38, v38
    v_exp_f32 v39, v39
    v_exp_f32 v40, v40
    v_exp_f32 v41, v41
    v_exp_f32 v42, v42
    v_smfmac_f32_32x32x32_bf16 v[64:79], v[92:95], v[32:39], v56
    v_and_or_b32 v104, s22, v107, v2
    v_exp_f32 v43, v43
    v_exp_f32 v44, v44
    s_waitcnt lgkmcnt(0)
    s_mov_b64 exec, s[26:27]
    ds_read_b128 v[88:91], v105 offset:5120
    ds_read_b128 v[92:95], v105 offset:5376
    s_mov_b64 exec, -1
    s_nop 0
    v_mfma_f32_32x32x16_bf16 v[24:39], v[80:83], v[4:7], 0
    ds_read_b128 v[84:87], v105 offset:6144
    v_exp_f32 v45, v45
    v_exp_f32 v46, v46
    v_exp_f32 v47, v47
    v_exp_f32 v48, v48
    v_exp_f32 v49, v49
    v_exp_f32 v50, v50
    v_smfmac_f32_32x32x32_bf16 v[64:79], v[96:99], v[40:47], v56
    v_exp_f32 v51, v51
    v_exp_f32 v52, v52
    v_exp_f32 v53, v53
    v_exp_f32 v54, v54
    v_exp_f32 v55, v55
    v_exp_f32 v24, v24
    v_exp_f32 v25, v25
    v_exp_f32 v26, v26
    v_smfmac_f32_32x32x32_bf16 v[64:79], v[100:103], v[48:55], v56
    v_exp_f32 v27, v27
    v_exp_f32 v28, v28
    s_waitcnt lgkmcnt(0)
    s_mov_b64 exec, s[26:27]
    ds_read_b128 v[96:99], v105 offset:7168
    ds_read_b128 v[100:103], v105 offset:7424
    s_mov_b64 exec, -1
    s_nop 0
    v_mfma_f32_32x32x16_bf16 v[40:55], v[84:87], v[4:7], 0
    ds_read_b128 v[80:83], v104 offset:0
    v_exp_f32 v29, v29
    v_exp_f32 v30, v30
    v_exp_f32 v31, v31
    v_exp_f32 v32, v32
    v_exp_f32 v33, v33
    v_exp_f32 v34, v34
    v_smfmac_f32_32x32x32_bf16 v[64:79], v[88:91], v[24:31], v56
    v_exp_f32 v35, v35
    v_exp_f32 v36, v36
    v_exp_f32 v37, v37
    v_exp_f32 v38, v38
    v_exp_f32 v39, v39
    v_exp_f32 v40, v40
    v_exp_f32 v41, v41
    v_exp_f32 v42, v42
    v_smfmac_f32_32x32x32_bf16 v[64:79], v[92:95], v[32:39], v56
    s_cmp_lg_u32 s22, s37
    v_exp_f32 v43, v43
    v_exp_f32_e64 v44, v44
    s_waitcnt lgkmcnt(0)
    s_mov_b64 exec, s[26:27]
    ds_read_b128 v[88:91], v104 offset:1024
    ds_read_b128 v[92:95], v104 offset:1280
    s_mov_b64 exec, -1
    s_nop 0
    v_mfma_f32_32x32x16_bf16 v[24:39], v[80:83], v[4:7], 0
    ds_read_b128 v[84:87], v104 offset:2048
    v_exp_f32 v45, v45
    v_exp_f32 v46, v46
    v_exp_f32 v47, v47
    v_exp_f32 v48, v48
    v_exp_f32 v49, v49
    v_exp_f32 v50, v50
    v_smfmac_f32_32x32x32_bf16 v[64:79], v[96:99], v[40:47], v56
    v_exp_f32 v51, v51
    v_exp_f32 v52, v52
    v_exp_f32 v53, v53
    v_exp_f32 v54, v54
    v_exp_f32 v55, v55
    s_cbranch_scc1 L_k2_loopa
    s_cmp_lg_u32 s37, s39
    s_cbranch_scc1 L_k2_seg
    v_smfmac_f32_32x32x32_bf16 v[64:79], v[100:103], v[48:55], v56
    s_waitcnt lgkmcnt(0)
    s_mov_b32 s19, 0x2b800000
    s_mov_b32 s20, 0x53800000
    s_nop 8
    v_mov_b32 v106, v72
    v_fma_f32 v106, v64, 0, v106
    v_fma_f32 v106, v65, 0, v106
    v_fma_f32 v106, v66, 0, v106
    v_fma_f32 v106, v67, 0, v106
    v_fma_f32 v106, v68, 0, v106
    v_fma_f32 v106, v69, 0, v106
    v_fma_f32 v106, v70, 0, v106
    v_fma_f32 v106, v71, 0, v106
    v_cmp_nle_f32 vcc, s19, v106
    v_cmp_nge_f32 s[28:29], s20, v106
    s_nop 3
    s_or_b64 vcc, vcc, s[28:29]
    s_cbranch_scc1 L_k2_slow
L_k2_fin:
    v_rcp_f32 v106, v72
    s_lshl_b32 s19, s18, 5
    s_add_u32 s19, s19, s17
    s_lshl_b32 s19, s19, 10
    s_add_u32 s19, s19, 6291456
    v_mul_f32 v64, v64, v106
    v_mul_f32 v65, v65, v106
    v_mul_f32 v66, v66, v106
    v_mul_f32 v67, v67, v106
    v_mul_f32 v68, v68, v106
    v_mul_f32 v69, v69, v106
    v_mul_f32 v70, v70, v106
    v_mul_f32 v71, v71, v106
    v_cvt_pk_bf16_f32 v56, v64, v65
    v_cvt_pk_bf16_f32 v57, v66, v67
    v_cvt_pk_bf16_f32 v58, v68, v69
    v_cvt_pk_bf16_f32 v59, v70, v71
    buffer_store_dwordx4 v[56:59], v2, s[4:7], s19 offen sc1
    s_endpgm
L_k2_bar:
    s_barrier
    s_mov_b64 vcc, -1
    s_branch L_k2_barx
L_k2_seg:
    s_cmp_eq_u32 s37, s38
    s_cbranch_scc1 L_k2_seg2
    s_mov_b32 s37, s38
L_k2_poll:
    v_mov_b32 v106, 163780
    ds_read_b32 v106, v106
    s_waitcnt lgkmcnt(0)
    v_readfirstlane_b32 s19, v106
    s_cmp_lt_u32 s19, 4
    s_cbranch_scc1 L_k2_poll
    s_branch L_k2_loopa
L_k2_seg2:
    s_setprio 0
    s_mov_b32 s37, s39
    s_branch L_k2_loopa
L_k2_slow:
    v_mov_b32 v104, v2
    v_mov_b32 v106, 0xff800000
    s_mov_b32 s21, 0
L_k2_max:
    ds_read_b128 v[80:83], v104
    v_add_u32 v104, 2048, v104
    s_waitcnt lgkmcnt(0)
    v_mfma_f32_32x32x16_bf16 v[24:39], v[80:83], v[4:7], 0
    s_add_u32 s21, s21, 1
    s_nop 10
    v_max3_f32 v106, v24, v25, v106
    v_max3_f32 v106, v26, v27, v106
    v_max3_f32 v106, v28, v29, v106
    v_max3_f32 v106, v30, v31, v106
    v_max3_f32 v106, v32, v33, v106
    v_max3_f32 v106, v34, v35, v106
    v_max3_f32 v106, v36, v37, v106
    v_max3_f32 v106, v38, v39, v106
    s_cmp_lt_u32 s21, 64
    s_cbranch_scc1 L_k2_max
    v_xor_b32 v104, 32, v1
    v_lshlrev_b32 v104, 2, v104
    ds_bpermute_b32 v105, v104, v106
    s_waitcnt lgkmcnt(0)
    v_max_f32 v106, v106, v105
    v_sub_f32 v8, 0, v106
    v_sub_f32 v9, 0, v106
    v_sub_f32 v10, 0, v106
    v_sub_f32 v11, 0, v106
    v_sub_f32 v12, 0, v106
    v_sub_f32 v13, 0, v106
    v_sub_f32 v14, 0, v106
    v_sub_f32 v15, 0, v106
    v_sub_f32 v16, 0, v106
    v_sub_f32 v17, 0, v106
    v_sub_f32 v18, 0, v106
    v_sub_f32 v19, 0, v106
    v_sub_f32 v20, 0, v106
    v_sub_f32 v21, 0, v106
    v_sub_f32 v22, 0, v106
    v_sub_f32 v23, 0, v106
    s_mov_b64 exec, s[26:27]
    v_mov_b32 v100, 0
    v_mov_b32 v101, 0
    v_mov_b32 v102, 0
    v_mov_b32 v103, 0
    s_mov_b64 exec, -1
    v_mov_b32 v64, 0
    v_mov_b32 v65, 0
    v_mov_b32 v66, 0
    v_mov_b32 v67, 0
    v_mov_b32 v68, 0
    v_mov_b32 v69, 0
    v_mov_b32 v70, 0
    v_mov_b32 v71, 0
    v_mov_b32 v72, 0
    v_mov_b32 v73, 0
    v_mov_b32 v74, 0
    v_mov_b32 v75, 0
    v_mov_b32 v76, 0
    v_mov_b32 v77, 0
    v_mov_b32 v78, 0
    v_mov_b32 v79, 0
    v_mov_b64 v[48:49], 0
    v_mov_b64 v[50:51], 0
    v_mov_b64 v[52:53], 0
    v_mov_b64 v[54:55], 0
    v_mov_b32 v56, 0xdddddddd
    v_add_u32 v104, s33, v2
    s_mov_b32 s22, s33
    s_mov_b32 s37, s39
    ds_read_b128 v[80:83], v104
    ds_read_b128 v[84:87], v104 offset:2048
    s_mov_b64 exec, s[26:27]
    ds_read_b128 v[88:91], v104 offset:1024
    ds_read_b128 v[92:95], v104 offset:1280
    s_mov_b64 exec, -1
    s_waitcnt lgkmcnt(3)
    v_mfma_f32_32x32x16_bf16 v[24:39], v[80:83], v[4:7], v[8:23]
    s_waitcnt lgkmcnt(0)
    s_nop 7
    s_nop 3
    .p2align 6
L_k2_loopb:
    v_exp_f32 v24, v24
    v_exp_f32 v25, v25
    v_exp_f32_e64 v26, v26
    v_smfmac_f32_32x32x32_bf16 v[64:79], v[100:103], v[48:55], v56
    s_add_u32 s22, s22, s36
    v_exp_f32 v27, v27
    v_exp_f32_e64 v28, v28
    s_waitcnt lgkmcnt(0)
    s_mov_b64 exec, s[26:27]
    ds_read_b128 v[96:99], v104 offset:3072
    ds_read_b128 v[100:103], v104 offset:3328
    s_mov_b64 exec, -1
    s_nop 0
    v_mfma_f32_32x32x16_bf16 v[40:55], v[84:87], v[4:7], v[8:23]
    ds_read_b128 v[80:83], v104 offset:4096
    v_exp_f32 v29, v29
    v_exp_f32 v30, v30
    v_exp_f32 v31, v31
    v_exp_f32 v32, v32
    v_exp_f32 v33, v33
    v_exp_f32 v34, v34
    v_smfmac_f32_32x32x32_bf16 v[64:79], v[88:91], v[24:31], v56
    v_exp_f32 v35, v35
    v_exp_f32 v36, v36
    v_exp_f32 v37, v37
    v_exp_f32 v38, v38
    v_exp_f32 v39, v39
    v_exp_f32 v40, v40
    v_exp_f32 v41, v41
    v_exp_f32 v42, v42
    v_smfmac_f32_32x32x32_bf16 v[64:79], v[92:95], v[32:39], v56
    v_and_or_b32 v105, s22, v107, v2
    v_exp_f32 v43, v43
    v_exp_f32 v44, v44
    s_waitcnt lgkmcnt(0)
    s_mov_b64 exec, s[26:27]
    ds_read_b128 v[88:91], v104 offset:5120
    ds_read_b128 v[92:95], v104 offset:5376
    s_mov_b64 exec, -1
    s_nop 0
    v_mfma_f32_32x32x16_bf16 v[24:39], v[80:83], v[4:7], v[8:23]
    ds_read_b128 v[84:87], v104 offset:6144
    v_exp_f32 v45, v45
    v_exp_f32 v46, v46
    v_exp_f32 v47, v47
    v_exp_f32 v48, v48
    v_exp_f32 v49, v49
    v_exp_f32 v50, v50
    v_smfmac_f32_32x32x32_bf16 v[64:79], v[96:99], v[40:47], v56
    v_exp_f32 v51, v51
    v_exp_f32 v52, v52
    v_exp_f32 v53, v53
    v_exp_f32 v54, v54
    v_exp_f32 v55, v55
    v_exp_f32 v24, v24
    v_exp_f32 v25, v25
    v_exp_f32 v26, v26
    v_smfmac_f32_32x32x32_bf16 v[64:79], v[100:103], v[48:55], v56
    v_exp_f32 v27, v27
    v_exp_f32 v28, v28
    s_waitcnt lgkmcnt(0)
    s_mov_b64 exec, s[26:27]
    ds_read_b128 v[96:99], v104 offset:7168
    ds_read_b128 v[100:103], v104 offset:7424
    s_mov_b64 exec, -1
    s_nop 0
    v_mfma_f32_32x32x16_bf16 v[40:55], v[84:87], v[4:7], v[8:23]
    ds_read_b128 v[80:83], v105 offset:0
    v_exp_f32 v29, v29
    v_exp_f32 v30, v30
    v_exp_f32 v31, v31
    v_exp_f32 v32, v32
    v_exp_f32 v33, v33
    v_exp_f32 v34, v34
    v_smfmac_f32_32x32x32_bf16 v[64:79], v[88:91], v[24:31], v56
    v_exp_f32 v35, v35
    v_exp_f32 v36, v36
    v_exp_f32 v37, v37
    v_exp_f32 v38, v38
    v_exp_f32 v39, v39
    v_exp_f32 v40, v40
    v_exp_f32 v41, v41
    v_exp_f32 v42, v42
    v_smfmac_f32_32x32x32_bf16 v[64:79], v[92:95], v[32:39], v56
    v_exp_f32 v43, v43
    v_exp_f32 v44, v44
    s_waitcnt lgkmcnt(0)
    s_mov_b64 exec, s[26:27]
    ds_read_b128 v[88:91], v105 offset:1024
    ds_read_b128 v[92:95], v105 offset:1280
    s_mov_b64 exec, -1
    s_nop 0
    v_mfma_f32_32x32x16_bf16 v[24:39], v[80:83], v[4:7], v[8:23]
    ds_read_b128 v[84:87], v105 offset:2048
    v_exp_f32 v45, v45
    v_exp_f32 v46, v46
    v_exp_f32 v47, v47
    v_exp_f32 v48, v48
    v_exp_f32 v49, v49
    v_exp_f32 v50, v50
    v_smfmac_f32_32x32x32_bf16 v[64:79], v[96:99], v[40:47], v56
    v_exp_f32 v51, v51
    v_exp_f32 v52, v52
    v_exp_f32 v53, v53
    v_exp_f32 v54, v54
    v_exp_f32 v55, v55
    v_exp_f32 v24, v24
    v_exp_f32 v25, v25
    v_exp_f32 v26, v26
    v_smfmac_f32_32x32x32_bf16 v[64:79], v[100:103], v[48:55], v56
    s_add_u32 s22, s22, s36
    v_exp_f32 v27, v27
    v_exp_f32_e64 v28, v28
    s_waitcnt lgkmcnt(0)
    s_mov_b64 exec, s[26:27]
    ds_read_b128 v[96:99], v105 offset:3072
    ds_read_b128 v[100:103], v105 offset:3328
    s_mov_b64 exec, -1
    s_nop 0
    v_mfma_f32_32x32x16_bf16 v[40:55], v[84:87], v[4:7], v[8:23]
    ds_read_b128 v[80:83], v105 offset:4096
    v_exp_f32 v29, v29
    v_exp_f32 v30, v30
    v_exp_f32 v31, v31
    v_exp_f32 v32, v32
    v_exp_f32 v33, v33
    v_exp_f32 v34, v34
    v_smfmac_f32_32x32x32_bf16 v[64:79], v[88:91], v[24:31], v56
    v_exp_f32 v35, v35
    v_exp_f32 v36, v36
    v_exp_f32 v37, v37
    v_exp_f32 v38, v38
    v_exp_f32 v39, v39
    v_exp_f32 v40, v40
    v_exp_f32 v41, v41
    v_exp_f32 v42, v42
    v_smfmac_f32_32x32x32_bf16 v[64:79], v[92:95], v[32:39], v56
    v_and_or_b32 v104, s22, v107, v2
    v_exp_f32 v43, v43
    v_exp_f32 v44, v44
    s_waitcnt lgkmcnt(0)
    s_mov_b64 exec, s[26:27]
    ds_read_b128 v[88:91], v105 offset:5120
    ds_read_b128 v[92:95], v105 offset:5376
    s_mov_b64 exec, -1
    s_nop 0
    v_mfma_f32_32x32x16_bf16 v[24:39], v[80:83], v[4:7], v[8:23]
    ds_read_b128 v[84:87], v105 offset:6144
    v_exp_f32 v45, v45
    v_exp_f32 v46, v46
    v_exp_f32 v47, v47
    v_exp_f32 v48, v48
    v_exp_f32 v49, v49
    v_exp_f32 v50, v50
    v_smfmac_f32_32x32x32_bf16 v[64:79], v[96:99], v[40:47], v56
    v_exp_f32 v51, v51
    v_exp_f32 v52, v52
    v_exp_f32 v53, v53
    v_exp_f32 v54, v54
    v_exp_f32 v55, v55
    v_exp_f32 v24, v24
    v_exp_f32 v25, v25
    v_exp_f32 v26, v26
    v_smfmac_f32_32x32x32_bf16 v[64:79], v[100:103], v[48:55], v56
    v_exp_f32 v27, v27
    v_exp_f32 v28, v28
    s_waitcnt lgkmcnt(0)
    s_mov_b64 exec, s[26:27]
    ds_read_b128 v[96:99], v105 offset:7168
    ds_read_b128 v[100:103], v105 offset:7424
    s_mov_b64 exec, -1
    s_nop 0
    v_mfma_f32_32x32x16_bf16 v[40:55], v[84:87], v[4:7], v[8:23]
    ds_read_b128 v[80:83], v104 offset:0
    v_exp_f32 v29, v29
    v_exp_f32 v30, v30
    v_exp_f32 v31, v31
    v_exp_f32 v32, v32
    v_exp_f32 v33, v33
    v_exp_f32 v34, v34
    v_smfmac_f32_32x32x32_bf16 v[64:79], v[88:91], v[24:31], v56
    v_exp_f32 v35, v35
    v_exp_f32 v36, v36
    v_exp_f32 v37, v37
    v_exp_f32 v38, v38
    v_exp_f32 v39, v39
    v_exp_f32 v40, v40
    v_exp_f32 v41, v41
    v_exp_f32 v42, v42
    v_smfmac_f32_32x32x32_bf16 v[64:79], v[92:95], v[32:39], v56
    s_cmp_lg_u32 s22, s37
    v_exp_f32 v43, v43
    v_exp_f32_e64 v44, v44
    s_waitcnt lgkmcnt(0)
    s_mov_b64 exec, s[26:27]
    ds_read_b128 v[88:91], v104 offset:1024
    ds_read_b128 v[92:95], v104 offset:1280
    s_mov_b64 exec, -1
    s_nop 0
    v_mfma_f32_32x32x16_bf16 v[24:39], v[80:83], v[4:7], v[8:23]
    ds_read_b128 v[84:87], v104 offset:2048
    v_exp_f32 v45, v45
    v_exp_f32 v46, v46
    v_exp_f32 v47, v47
    v_exp_f32 v48, v48
    v_exp_f32 v49, v49
    v_exp_f32 v50, v50
    v_smfmac_f32_32x32x32_bf16 v[64:79], v[96:99], v[40:47], v56
    v_exp_f32 v51, v51
    v_exp_f32 v52, v52
    v_exp_f32 v53, v53
    v_exp_f32 v54, v54
    v_exp_f32 v55, v55
    s_cbranch_scc1 L_k2_loopb
    s_nop 1
    v_smfmac_f32_32x32x32_bf16 v[64:79], v[100:103], v[48:55], v56
    s_waitcnt lgkmcnt(0)
    s_nop 7
    s_nop 3
    s_branch L_k2_fin
L_k2_conv:
    s_setprio 3
    s_sub_u32 s36, s16, 8
    s_lshl_b32 s44, s36, 12
    s_add_u32 s44, s44, 65536
    s_mov_b32 s45, s32
    v_mov_b32 v78, 0
    v_mov_b32 v79, 0
    v_mov_b32 v90, 163776
    v_mov_b32 v91, 1
    ds_write_b64 v90, v[78:79]
    s_waitcnt lgkmcnt(0)
    s_mov_b32 s10, 0x00200000
    s_mov_b32 s11, 0x00020000
    s_mov_b32 s42, 0x00080000
    s_mov_b32 s43, 0x00020000
    s_lshl_b32 s24, s19, 5
    s_add_u32 s24, s24, s20
    s_lshl_b32 s23, s20, 14
    s_lshr_b32 s37, s36, 1
    s_and_b32 s38, s36, 1
    s_mul_i32 s39, s37, 13600
    s_add_u32 s39, s39, 131072
    s_mul_i32 s35, s38, 4160
    s_add_u32 s35, s35, s39
    s_add_u32 s35, s35, 64
    s_lshl_b32 s20, s24, 1
    s_add_u32 s20, s20, s37
    s_lshl_b32 s20, s20, 12
    s_add_u32 s20, s20, 8388608
    s_lshl_b32 s21, s38, 1
    s_sub_u32 s20, s20, s21
    s_mov_b32 s47, s35
    s_mov_b32 s48, s20
    v_and_b32 v85, 31, v1
    v_lshrrev_b32 v86, 5, v1
    s_lshl_b32 s19, s24, 2
    v_lshlrev_b32 v87, 12, v86
    v_lshl_add_u32 v76, v85, 15, v87
    s_lshl_b32 s32, s37, 20
    s_lshl_b32 s33, s38, 14
    s_add_u32 s32, s32, s33
    s_add_u32 s33, s32, s19
    s_add_u32 s34, s33, 8192
    s_mul_i32 s20, s38, 80
    s_add_u32 s20, s20, s39
    s_add_u32 s20, s20, 13376
    v_min_u32 v87, 35, v1
    v_lshl_add_u32 v92, v87, 2, s20
    s_sub_u32 s20, s35, 64
    v_lshl_add_u32 v88, v1, 2, s20
    v_cmp_gt_u32 vcc, 16, v1
    s_nop 1
    v_cndmask_b32 v92, v92, v88, vcc
    ds_write_b32 v92, v78
    s_lshl_b32 s20, s38, 1
    s_add_u32 s20, s20, s35
    s_sub_u32 s20, s20, 2
    v_mov_b32 v80, s20
    v_mul_u32_u24 v87, 80, v85
    v_lshl_add_u32 v87, v86, 3, v87
    s_mul_i32 s35, s37, 2560
    s_lshl_b32 s20, s38, 5
    s_add_u32 s35, s35, s20
    s_sub_u32 s35, 144472, s35
    v_sub_u32 v77, s35, v87
    s_barrier
    s_add_u32 m0, s44, 0
    s_add_u32 s46, s45, m0
    buffer_load_dwordx4 v2, s[4:7], s46 offen offset:0 lds
    buffer_load_dwordx4 v2, s[4:7], s46 offen offset:1024 lds
    buffer_load_dwordx4 v2, s[4:7], s46 offen offset:2048 lds
    buffer_load_dwordx4 v2, s[4:7], s46 offen offset:3072 lds
    s_add_u32 m0, s44, 16384
    s_add_u32 s46, s45, m0
    buffer_load_dwordx4 v2, s[4:7], s46 offen offset:0 lds
    buffer_load_dwordx4 v2, s[4:7], s46 offen offset:1024 lds
    buffer_load_dwordx4 v2, s[4:7], s46 offen offset:2048 lds
    buffer_load_dwordx4 v2, s[4:7], s46 offen offset:3072 lds
    s_add_u32 m0, s44, 32768
    s_add_u32 s46, s45, m0
    buffer_load_dwordx4 v2, s[4:7], s46 offen offset:0 lds
    buffer_load_dwordx4 v2, s[4:7], s46 offen offset:1024 lds
    buffer_load_dwordx4 v2, s[4:7], s46 offen offset:2048 lds
    buffer_load_dwordx4 v2, s[4:7], s46 offen offset:3072 lds
    s_add_u32 m0, s44, 49152
    s_add_u32 s46, s45, m0
    buffer_load_dwordx4 v2, s[4:7], s46 offen offset:0 lds
    buffer_load_dwordx4 v2, s[4:7], s46 offen offset:1024 lds
    buffer_load_dwordx4 v2, s[4:7], s46 offen offset:2048 lds
    buffer_load_dwordx4 v2, s[4:7], s46 offen offset:3072 lds
    s_mov_b32 m0, s47
    s_nop 0
    buffer_load_dwordx4 v2, s[4:7], s48 offen offset:0 lds
    buffer_load_dwordx4 v2, s[4:7], s48 offen offset:1024 lds
    buffer_load_dwordx4 v2, s[4:7], s48 offen offset:2048 lds
    buffer_load_dwordx4 v2, s[4:7], s48 offen offset:3072 lds
    s_waitcnt vmcnt(4)
    s_mov_b64 exec, 1
    ds_add_u32 v90, v91 offset:4
    s_mov_b64 exec, -1
    buffer_load_dword v4, v76, s[8:11], s33 offen offset:0
    buffer_load_dword v5, v76, s[8:11], s33 offen offset:1024
    buffer_load_dword v6, v76, s[8:11], s33 offen offset:2048
    buffer_load_dword v7, v76, s[8:11], s33 offen offset:3072
    buffer_load_dword v8, v76, s[8:11], s34 offen offset:0
    buffer_load_dword v9, v76, s[8:11], s34 offen offset:1024
    buffer_load_dword v10, v76, s[8:11], s34 offen offset:2048
    buffer_load_dword v11, v76, s[8:11], s34 offen offset:3072
    v_and_b32 v87, 1, v85
    v_and_b32 v88, 30, v85
    v_lshlrev_b32 v88, 1, v88
    v_lshl_add_u32 v88, v86, 4, v88
    v_mul_u32_u24 v87, 4160, v87
    v_sub_u32 v88, v88, v87
    s_lshl_b32 s20, s38, 10
    s_add_u32 s20, s20, s39
    s_add_u32 s20, s20, 4164
    v_add_u32 v81, s20, v88
    v_add_u32 v82, 2048, v81
    v_mul_u32_u24 v87, 80, v85
    v_lshlrev_b32 v88, 4, v86
    v_sub_u32 v87, v88, v87
    s_mul_i32 s20, s38, 1280
    s_add_u32 s20, s20, s39
    s_add_u32 s20, s20, 10800
    v_add_u32 v84, s20, v87
    s_add_u32 s35, s39, 13440
    v_add_u32 v83, 2560, v84
    v_min_u32 v83, s35, v83
    v_add_u32 v89, 131072, v2
    v_mov_b32 v12, 0
    v_mov_b32 v13, 0
    v_mov_b32 v14, 0
    v_mov_b32 v15, 0
    v_mov_b32 v16, 0
    v_mov_b32 v17, 0
    v_mov_b32 v18, 0
    v_mov_b32 v19, 0
    v_mov_b32 v20, 0
    v_mov_b32 v21, 0
    v_mov_b32 v22, 0
    v_mov_b32 v23, 0
    v_mov_b32 v24, 0
    v_mov_b32 v25, 0
    v_mov_b32 v26, 0
    v_mov_b32 v27, 0
    v_mov_b32 v28, 0
    v_mov_b32 v29, 0
    v_mov_b32 v30, 0
    v_mov_b32 v31, 0
    v_mov_b32 v32, 0
    v_mov_b32 v33, 0
    v_mov_b32 v34, 0
    v_mov_b32 v35, 0
    v_mov_b32 v36, 0
    v_mov_b32 v37, 0
    v_mov_b32 v38, 0
    v_mov_b32 v39, 0
    v_mov_b32 v40, 0
    v_mov_b32 v41, 0
    v_mov_b32 v42, 0
    v_mov_b32 v43, 0
    s_waitcnt vmcnt(8)
    ds_write_b16 v80, v78
    s_waitcnt vmcnt(7)
    ds_write_b16 v77, v4 offset:22
    ds_write_b16_d16_hi v77, v4 offset:13622
    s_waitcnt vmcnt(6)
    ds_write_b16 v77, v5 offset:20
    ds_write_b16_d16_hi v77, v5 offset:13620
    s_waitcnt vmcnt(5)
    ds_write_b16 v77, v6 offset:18
    ds_write_b16_d16_hi v77, v6 offset:13618
    s_waitcnt vmcnt(4)
    ds_write_b16 v77, v7 offset:16
    ds_write_b16_d16_hi v77, v7 offset:13616
    s_waitcnt vmcnt(3)
    ds_write_b16 v77, v8 offset:6
    ds_write_b16_d16_hi v77, v8 offset:13606
    s_waitcnt vmcnt(2)
    ds_write_b16 v77, v9 offset:4
    ds_write_b16_d16_hi v77, v9 offset:13604
    s_waitcnt vmcnt(1)
    ds_write_b16 v77, v10 offset:2
    ds_write_b16_d16_hi v77, v10 offset:13602
    s_waitcnt vmcnt(0)
    ds_write_b16 v77, v11 offset:0
    ds_write_b16_d16_hi v77, v11 offset:13600
    s_lshl_b32 s20, s36, 12
    s_add_u32 s20, s20, s23
    buffer_load_dwordx4 v[96:99], v2, s[40:43], s20 offen offset:0
    buffer_load_dwordx4 v[100:103], v2, s[40:43], s20 offen offset:1024
    buffer_load_dwordx4 v[104:107], v2, s[40:43], s20 offen offset:2048
    buffer_load_dwordx4 v[108:111], v2, s[40:43], s20 offen offset:3072
    s_waitcnt lgkmcnt(0)
    s_mov_b64 exec, 1
    ds_add_u32 v90, v91
L_k2_spin1:
    ds_read_b32 v87, v90
    s_waitcnt lgkmcnt(0)
    v_readfirstlane_b32 s20, v87
    s_cmp_lt_u32 s20, 4
    s_cbranch_scc1 L_k2_spin1
    s_mov_b64 exec, -1
    s_mov_b32 s21, 0
L_k2_cloop:
    ds_read2_b32 v[44:45], v81 offset0:0 offset1:1
    ds_read2_b32 v[46:47], v81 offset0:2 offset1:3
    ds_read_b128 v[56:59], v84 offset:0
    s_waitcnt lgkmcnt(0)
    v_mfma_f32_32x32x16_bf16 v[28:43], v[44:47], v[56:59], v[28:43]
    ds_read_b128 v[52:55], v83 offset:0
    s_waitcnt lgkmcnt(0)
    v_mfma_f32_32x32x16_bf16 v[12:27], v[44:47], v[52:55], v[12:27]
    ds_read2_b32 v[48:49], v82 offset0:0 offset1:1
    ds_read2_b32 v[50:51], v82 offset0:2 offset1:3
    s_waitcnt lgkmcnt(0)
    v_mfma_f32_32x32x16_bf16 v[28:43], v[48:51], v[52:55], v[28:43]
    ds_read2_b32 v[60:61], v81 offset0:8 offset1:9
    ds_read2_b32 v[62:63], v81 offset0:10 offset1:11
    ds_read_b128 v[72:75], v84 offset:32
    s_waitcnt lgkmcnt(0)
    v_mfma_f32_32x32x16_bf16 v[28:43], v[60:63], v[72:75], v[28:43]
    ds_read_b128 v[68:71], v83 offset:32
    s_waitcnt lgkmcnt(0)
    v_mfma_f32_32x32x16_bf16 v[12:27], v[60:63], v[68:71], v[12:27]
    ds_read2_b32 v[64:65], v82 offset0:8 offset1:9
    ds_read2_b32 v[66:67], v82 offset0:10 offset1:11
    s_waitcnt lgkmcnt(0)
    v_mfma_f32_32x32x16_bf16 v[28:43], v[64:67], v[68:71], v[28:43]
    ds_read2_b32 v[44:45], v81 offset0:16 offset1:17
    ds_read2_b32 v[46:47], v81 offset0:18 offset1:19
    ds_read_b128 v[56:59], v84 offset:80
    s_waitcnt lgkmcnt(0)
    v_mfma_f32_32x32x16_bf16 v[28:43], v[44:47], v[56:59], v[28:43]
    ds_read_b128 v[52:55], v83 offset:80
    s_waitcnt lgkmcnt(0)
    v_mfma_f32_32x32x16_bf16 v[12:27], v[44:47], v[52:55], v[12:27]
    ds_read2_b32 v[48:49], v82 offset0:16 offset1:17
    ds_read2_b32 v[50:51], v82 offset0:18 offset1:19
    s_waitcnt lgkmcnt(0)
    v_mfma_f32_32x32x16_bf16 v[28:43], v[48:51], v[52:55], v[28:43]
    ds_read2_b32 v[60:61], v81 offset0:24 offset1:25
    ds_read2_b32 v[62:63], v81 offset0:26 offset1:27
    ds_read_b128 v[72:75], v84 offset:112
    s_waitcnt lgkmcnt(0)
    v_mfma_f32_32x32x16_bf16 v[28:43], v[60:63], v[72:75], v[28:43]
    ds_read_b128 v[68:71], v83 offset:112
    s_waitcnt lgkmcnt(0)
    v_mfma_f32_32x32x16_bf16 v[12:27], v[60:63], v[68:71], v[12:27]
    ds_read2_b32 v[64:65], v82 offset0:24 offset1:25
    ds_read2_b32 v[66:67], v82 offset0:26 offset1:27
    v_add_u32 v81, 128, v81
    v_add_u32 v82, 128, v82
    v_add_u32 v84, 160, v84
    v_add_u32 v83, 160, v83
    v_min_u32 v83, s35, v83
    s_add_u32 s21, s21, 1
    s_cmp_lt_u32 s21, 8
    s_waitcnt lgkmcnt(0)
    v_mfma_f32_32x32x16_bf16 v[28:43], v[64:67], v[68:71], v[28:43]
    s_cbranch_scc1 L_k2_cloop
    s_waitcnt lgkmcnt(0)
    s_mov_b64 exec, 1
    ds_add_u32 v90, v91
L_k2_spin2:
    ds_read_b32 v87, v90
    s_waitcnt lgkmcnt(0)
    v_readfirstlane_b32 s20, v87
    s_cmp_lt_u32 s20, 8
    s_cbranch_scc1 L_k2_spin2
    s_mov_b64 exec, -1
    v_lshlrev_b32 v76, 4, v86
    v_lshl_add_u32 v76, v85, 5, v76
    s_lshl2_add_u32 s32, s24, s36
    s_lshl_b32 s32, s32, 11
    s_add_u32 s32, s32, 12582912
    s_cmp_eq_u32 s36, 1
    s_cbranch_scc1 L_k2_x1
    s_cmp_eq_u32 s36, 2
    s_cbranch_scc1 L_k2_x2
    s_cmp_eq_u32 s36, 3
    s_cbranch_scc1 L_k2_x3
    ds_write_b128 v89, v[20:23] offset:6144
    ds_write_b128 v89, v[24:27] offset:7168
    ds_write_b128 v89, v[28:31] offset:12288
    ds_write_b128 v89, v[32:35] offset:13312
    ds_write_b128 v89, v[36:39] offset:18432
    ds_write_b128 v89, v[40:43] offset:19456
    s_waitcnt lgkmcnt(0)
    s_mov_b64 exec, 1
    ds_add_u32 v90, v91
L_k2_spin3:
    ds_read_b32 v87, v90
    s_waitcnt lgkmcnt(0)
    v_readfirstlane_b32 s20, v87
    s_cmp_lt_u32 s20, 12
    s_cbranch_scc1 L_k2_spin3
    s_mov_b64 exec, -1
    ds_read_b128 v[52:55], v89 offset:0
    ds_read_b128 v[56:59], v89 offset:1024
    ds_read_b128 v[60:63], v89 offset:2048
    ds_read_b128 v[64:67], v89 offset:3072
    ds_read_b128 v[68:71], v89 offset:4096
    ds_read_b128 v[72:75], v89 offset:5120
    s_waitcnt lgkmcnt(0)
    v_add_f32 v12, v12, v52
    v_add_f32 v60, v60, v68
    v_cvt_pk_bf16_f32 v4, v12, v60
    v_add_f32 v13, v13, v53
    v_add_f32 v61, v61, v69
    v_cvt_pk_bf16_f32 v5, v13, v61
    v_add_f32 v14, v14, v54
    v_add_f32 v62, v62, v70
    v_cvt_pk_bf16_f32 v6, v14, v62
    v_add_f32 v15, v15, v55
    v_add_f32 v63, v63, v71
    v_cvt_pk_bf16_f32 v7, v15, v63
    buffer_store_dwordx4 v[4:7], v76, s[4:7], s32 offen offset:0 sc1
    v_add_f32 v16, v16, v56
    v_add_f32 v64, v64, v72
    v_cvt_pk_bf16_f32 v8, v16, v64
    v_add_f32 v17, v17, v57
    v_add_f32 v65, v65, v73
    v_cvt_pk_bf16_f32 v9, v17, v65
    v_add_f32 v18, v18, v58
    v_add_f32 v66, v66, v74
    v_cvt_pk_bf16_f32 v10, v18, v66
    v_add_f32 v19, v19, v59
    v_add_f32 v67, v67, v75
    v_cvt_pk_bf16_f32 v11, v19, v67
    buffer_store_dwordx4 v[8:11], v76, s[4:7], s32 offen offset:1024 sc1
    s_branch L_k2_cend
L_k2_x1:
    ds_write_b128 v89, v[12:15] offset:0
    ds_write_b128 v89, v[16:19] offset:1024
    ds_write_b128 v89, v[28:31] offset:14336
    ds_write_b128 v89, v[32:35] offset:15360
    ds_write_b128 v89, v[36:39] offset:20480
    ds_write_b128 v89, v[40:43] offset:21504
    s_waitcnt lgkmcnt(0)
    s_mov_b64 exec, 1
    ds_add_u32 v90, v91
L_k2_spin4:
    ds_read_b32 v87, v90
    s_waitcnt lgkmcnt(0)
    v_readfirstlane_b32 s20, v87
    s_cmp_lt_u32 s20, 12
    s_cbranch_scc1 L_k2_spin4
    s_mov_b64 exec, -1
    ds_read_b128 v[44:47], v89 offset:6144
    ds_read_b128 v[48:51], v89 offset:7168
    ds_read_b128 v[60:63], v89 offset:8192
    ds_read_b128 v[64:67], v89 offset:9216
    ds_read_b128 v[68:71], v89 offset:10240
    ds_read_b128 v[72:75], v89 offset:11264
    s_waitcnt lgkmcnt(0)
    v_add_f32 v44, v44, v20
    v_add_f32 v60, v60, v68
    v_cvt_pk_bf16_f32 v4, v44, v60
    v_add_f32 v45, v45, v21
    v_add_f32 v61, v61, v69
    v_cvt_pk_bf16_f32 v5, v45, v61
    v_add_f32 v46, v46, v22
    v_add_f32 v62, v62, v70
    v_cvt_pk_bf16_f32 v6, v46, v62
    v_add_f32 v47, v47, v23
    v_add_f32 v63, v63, v71
    v_cvt_pk_bf16_f32 v7, v47, v63
    buffer_store_dwordx4 v[4:7], v76, s[4:7], s32 offen offset:0 sc1
    v_add_f32 v48, v48, v24
    v_add_f32 v64, v64, v72
    v_cvt_pk_bf16_f32 v8, v48, v64
    v_add_f32 v49, v49, v25
    v_add_f32 v65, v65, v73
    v_cvt_pk_bf16_f32 v9, v49, v65
    v_add_f32 v50, v50, v26
    v_add_f32 v66, v66, v74
    v_cvt_pk_bf16_f32 v10, v50, v66
    v_add_f32 v51, v51, v27
    v_add_f32 v67, v67, v75
    v_cvt_pk_bf16_f32 v11, v51, v67
    buffer_store_dwordx4 v[8:11], v76, s[4:7], s32 offen offset:1024 sc1
    s_branch L_k2_cend
L_k2_x2:
    ds_write_b128 v89, v[12:15] offset:2048
    ds_write_b128 v89, v[16:19] offset:3072
    ds_write_b128 v89, v[20:23] offset:8192
    ds_write_b128 v89, v[24:27] offset:9216
    ds_write_b128 v89, v[36:39] offset:22528
    ds_write_b128 v89, v[40:43] offset:23552
    s_waitcnt lgkmcnt(0)
    s_mov_b64 exec, 1
    ds_add_u32 v90, v91
L_k2_spin5:
    ds_read_b32 v87, v90
    s_waitcnt lgkmcnt(0)
    v_readfirstlane_b32 s20, v87
    s_cmp_lt_u32 s20, 12
    s_cbranch_scc1 L_k2_spin5
    s_mov_b64 exec, -1
    ds_read_b128 v[44:47], v89 offset:12288
    ds_read_b128 v[48:51], v89 offset:13312
    ds_read_b128 v[52:55], v89 offset:14336
    ds_read_b128 v[56:59], v89 offset:15360
    ds_read_b128 v[68:71], v89 offset:16384
    ds_read_b128 v[72:75], v89 offset:17408
    s_waitcnt lgkmcnt(0)
    v_add_f32 v44, v44, v52
    v_add_f32 v28, v28, v68
    v_cvt_pk_bf16_f32 v4, v44, v28
    v_add_f32 v45, v45, v53
    v_add_f32 v29, v29, v69
    v_cvt_pk_bf16_f32 v5, v45, v29
    v_add_f32 v46, v46, v54
    v_add_f32 v30, v30, v70
    v_cvt_pk_bf16_f32 v6, v46, v30
    v_add_f32 v47, v47, v55
    v_add_f32 v31, v31, v71
    v_cvt_pk_bf16_f32 v7, v47, v31
    buffer_store_dwordx4 v[4:7], v76, s[4:7], s32 offen offset:0 sc1
    v_add_f32 v48, v48, v56
    v_add_f32 v32, v32, v72
    v_cvt_pk_bf16_f32 v8, v48, v32
    v_add_f32 v49, v49, v57
    v_add_f32 v33, v33, v73
    v_cvt_pk_bf16_f32 v9, v49, v33
    v_add_f32 v50, v50, v58
    v_add_f32 v34, v34, v74
    v_cvt_pk_bf16_f32 v10, v50, v34
    v_add_f32 v51, v51, v59
    v_add_f32 v35, v35, v75
    v_cvt_pk_bf16_f32 v11, v51, v35
    buffer_store_dwordx4 v[8:11], v76, s[4:7], s32 offen offset:1024 sc1
    s_branch L_k2_cend
L_k2_x3:
    ds_write_b128 v89, v[12:15] offset:4096
    ds_write_b128 v89, v[16:19] offset:5120
    ds_write_b128 v89, v[20:23] offset:10240
    ds_write_b128 v89, v[24:27] offset:11264
    ds_write_b128 v89, v[28:31] offset:16384
    ds_write_b128 v89, v[32:35] offset:17408
    s_waitcnt lgkmcnt(0)
    s_mov_b64 exec, 1
    ds_add_u32 v90, v91
L_k2_spin6:
    ds_read_b32 v87, v90
    s_waitcnt lgkmcnt(0)
    v_readfirstlane_b32 s20, v87
    s_cmp_lt_u32 s20, 12
    s_cbranch_scc1 L_k2_spin6
    s_mov_b64 exec, -1
    ds_read_b128 v[44:47], v89 offset:18432
    ds_read_b128 v[48:51], v89 offset:19456
    ds_read_b128 v[52:55], v89 offset:20480
    ds_read_b128 v[56:59], v89 offset:21504
    ds_read_b128 v[60:63], v89 offset:22528
    ds_read_b128 v[64:67], v89 offset:23552
    s_waitcnt lgkmcnt(0)
    v_add_f32 v44, v44, v52
    v_add_f32 v60, v60, v36
    v_cvt_pk_bf16_f32 v4, v44, v60
    v_add_f32 v45, v45, v53
    v_add_f32 v61, v61, v37
    v_cvt_pk_bf16_f32 v5, v45, v61
    v_add_f32 v46, v46, v54
    v_add_f32 v62, v62, v38
    v_cvt_pk_bf16_f32 v6, v46, v62
    v_add_f32 v47, v47, v55
    v_add_f32 v63, v63, v39
    v_cvt_pk_bf16_f32 v7, v47, v63
    buffer_store_dwordx4 v[4:7], v76, s[4:7], s32 offen offset:0 sc1
    v_add_f32 v48, v48, v56
    v_add_f32 v64, v64, v40
    v_cvt_pk_bf16_f32 v8, v48, v64
    v_add_f32 v49, v49, v57
    v_add_f32 v65, v65, v41
    v_cvt_pk_bf16_f32 v9, v49, v65
    v_add_f32 v50, v50, v58
    v_add_f32 v66, v66, v42
    v_cvt_pk_bf16_f32 v10, v50, v66
    v_add_f32 v51, v51, v59
    v_add_f32 v67, v67, v43
    v_cvt_pk_bf16_f32 v11, v51, v67
    buffer_store_dwordx4 v[8:11], v76, s[4:7], s32 offen offset:1024 sc1
L_k2_cend:
L_k2_end:
    s_endpgm
.globl concat_heads__ssm_conv_s4__mha_block__prompt_kernel
.p2align 8
.type concat_heads__ssm_conv_s4__mha_block__prompt_kernel,@function
concat_heads__ssm_conv_s4__mha_block__prompt_kernel:
    s_cmp_ge_u32 s2, 256
    s_cbranch_scc1 L_k3_end
    s_load_dwordx2 s[4:5], s[0:1], 112
    s_load_dwordx2 s[8:9], s[0:1], 88
    s_load_dwordx2 s[12:13], s[0:1], 96
    s_mov_b32 s6, 0x00e00000
    s_mov_b32 s7, 0x00020000
    s_mov_b32 s10, 0x00080000
    s_mov_b32 s11, 0x00020000
    s_mov_b32 s14, 0x00400000
    s_mov_b32 s15, 0x00020000
    v_and_b32 v1, 63, v0
    v_lshrrev_b32 v4, 6, v0
    s_nop 0
    v_readfirstlane_b32 s16, v4
    v_lshlrev_b32 v2, 4, v1
    s_and_b32 s19, s2, 7
    s_lshr_b32 s20, s2, 3
    s_lshl_b32 s17, s19, 2
    s_and_b32 s19, s20, 3
    s_add_u32 s17, s17, s19
    s_lshr_b32 s18, s20, 2
    s_and_b32 s21, s16, 1
    s_lshr_b32 s22, s16, 1
    s_lshl_b32 s17, s17, 1
    s_add_u32 s17, s17, s21
    s_lshl_b32 s23, s17, 15
    s_lshl_b32 s19, s22, 14
    s_add_u32 s23, s23, s19
    s_add_u32 s23, s23, 6291456
    v_bfe_u32 v4, v1, 4, 1
    v_lshlrev_b32 v4, 2, v4
    v_and_b32 v5, 7, v1
    v_xor_b32 v4, v4, v5
    v_lshlrev_b32 v4, 4, v4
    v_lshrrev_b32 v5, 3, v1
    v_lshl_add_u32 v3, v5, 10, v4
    s_lshl_b32 s19, s22, 8
    s_lshl_b32 s20, s21, 5
    s_add_u32 s19, s19, s20
    s_lshl_b32 s25, s19, 7
    s_lshl_b32 s24, s19, 10
    s_lshl_b32 s20, s18, 7
    s_add_u32 s24, s24, s20
    s_waitcnt lgkmcnt(0)
    s_add_u32 s26, s18, 0
    s_and_b32 s26, s26, 3
    s_lshl_b32 s27, s26, 12
    s_add_u32 s19, s23, s27
    buffer_load_dwordx4 v[44:47], v2, s[4:7], s19 offen offset:0
    buffer_load_dwordx4 v[48:51], v2, s[4:7], s19 offen offset:1024
    buffer_load_dwordx4 v[52:55], v2, s[4:7], s19 offen offset:2048
    buffer_load_dwordx4 v[56:59], v2, s[4:7], s19 offen offset:3072
    s_add_u32 m0, s25, 0
    s_lshl_b32 s27, s26, 16
    s_add_u32 s27, s27, s24
    s_add_u32 s19, s27, 0
    buffer_load_dwordx4 v3, s[8:11], s19 offen offset:0 lds
    s_add_u32 s19, s27, 7168
    buffer_load_dwordx4 v3, s[8:11], s19 offen offset:1024 lds
    s_add_u32 s19, s27, 14336
    buffer_load_dwordx4 v3, s[8:11], s19 offen offset:2048 lds
    s_add_u32 s19, s27, 21504
    buffer_load_dwordx4 v3, s[8:11], s19 offen offset:3072 lds
    s_add_u32 s26, s18, 1
    s_and_b32 s26, s26, 3
    s_lshl_b32 s27, s26, 12
    s_add_u32 s19, s23, s27
    buffer_load_dwordx4 v[60:63], v2, s[4:7], s19 offen offset:0
    buffer_load_dwordx4 v[64:67], v2, s[4:7], s19 offen offset:1024
    buffer_load_dwordx4 v[68:71], v2, s[4:7], s19 offen offset:2048
    buffer_load_dwordx4 v[72:75], v2, s[4:7], s19 offen offset:3072
    s_add_u32 m0, s25, 8192
    s_lshl_b32 s27, s26, 16
    s_add_u32 s27, s27, s24
    s_add_u32 s19, s27, 0
    buffer_load_dwordx4 v3, s[8:11], s19 offen offset:0 lds
    s_add_u32 s19, s27, 7168
    buffer_load_dwordx4 v3, s[8:11], s19 offen offset:1024 lds
    s_add_u32 s19, s27, 14336
    buffer_load_dwordx4 v3, s[8:11], s19 offen offset:2048 lds
    s_add_u32 s19, s27, 21504
    buffer_load_dwordx4 v3, s[8:11], s19 offen offset:3072 lds
    s_add_u32 s26, s18, 2
    s_and_b32 s26, s26, 3
    s_lshl_b32 s27, s26, 12
    s_add_u32 s19, s23, s27
    buffer_load_dwordx4 v[76:79], v2, s[4:7], s19 offen offset:0
    buffer_load_dwordx4 v[80:83], v2, s[4:7], s19 offen offset:1024
    buffer_load_dwordx4 v[84:87], v2, s[4:7], s19 offen offset:2048
    buffer_load_dwordx4 v[88:91], v2, s[4:7], s19 offen offset:3072
    s_add_u32 m0, s25, 16384
    s_lshl_b32 s27, s26, 16
    s_add_u32 s27, s27, s24
    s_add_u32 s19, s27, 0
    buffer_load_dwordx4 v3, s[8:11], s19 offen offset:0 lds
    s_add_u32 s19, s27, 7168
    buffer_load_dwordx4 v3, s[8:11], s19 offen offset:1024 lds
    s_add_u32 s19, s27, 14336
    buffer_load_dwordx4 v3, s[8:11], s19 offen offset:2048 lds
    s_add_u32 s19, s27, 21504
    buffer_load_dwordx4 v3, s[8:11], s19 offen offset:3072 lds
    s_add_u32 s26, s18, 3
    s_and_b32 s26, s26, 3
    s_lshl_b32 s27, s26, 12
    s_add_u32 s19, s23, s27
    buffer_load_dwordx4 v[92:95], v2, s[4:7], s19 offen offset:0
    buffer_load_dwordx4 v[96:99], v2, s[4:7], s19 offen offset:1024
    buffer_load_dwordx4 v[100:103], v2, s[4:7], s19 offen offset:2048
    buffer_load_dwordx4 v[104:107], v2, s[4:7], s19 offen offset:3072
    s_add_u32 m0, s25, 24576
    s_lshl_b32 s27, s26, 16
    s_add_u32 s27, s27, s24
    s_add_u32 s19, s27, 0
    buffer_load_dwordx4 v3, s[8:11], s19 offen offset:0 lds
    s_add_u32 s19, s27, 7168
    buffer_load_dwordx4 v3, s[8:11], s19 offen offset:1024 lds
    s_add_u32 s19, s27, 14336
    buffer_load_dwordx4 v3, s[8:11], s19 offen offset:2048 lds
    s_add_u32 s19, s27, 21504
    buffer_load_dwordx4 v3, s[8:11], s19 offen offset:3072 lds
    v_and_b32 v4, 31, v1
    v_lshrrev_b32 v5, 5, v1
    v_lshlrev_b32 v180, 13, v4
    v_lshl_add_u32 v180, v5, 4, v180
    s_lshr_b32 s26, s17, 5
    s_lshl_b32 s19, s18, 6
    s_add_u32 s19, s19, s26
    s_lshl2_add_u32 s19, s19, s16
    s_bfe_u32 s26, s17, 262145
    s_lshl4_add_u32 s19, s19, s26
    s_lshl_b32 s19, s19, 6
    s_add_u32 s19, s19, 12582912
    buffer_load_dwordx4 v[172:175], v180, s[4:7], s19 offen offset:0
    buffer_load_dwordx4 v[176:179], v180, s[4:7], s19 offen offset:32
    v_lshlrev_b32 v181, 2, v4
    v_lshl_add_u32 v181, v5, 13, v181
    s_lshr_b32 s26, s17, 1
    s_lshl3_add_u32 s26, s26, s16
    s_lshl_b32 s26, s26, 7
    s_add_u32 s26, s26, s18
    s_lshl_b32 s28, s26, 7
    s_add_u32 s29, s28, 4096
    s_add_u32 s30, s28, 65536
    s_add_u32 s31, s28, 69632
    v_lshrrev_b32 v4, 5, v1
    v_lshlrev_b32 v4, 10, v4
    v_bfe_u32 v5, v1, 2, 2
    v_lshl_add_u32 v4, v5, 7, v4
    v_bfe_u32 v5, v1, 3, 1
    v_lshl_add_u32 v4, v5, 6, v4
    v_bfe_u32 v5, v1, 4, 1
    v_lshl_add_u32 v4, v5, 5, v4
    v_and_b32 v5, 1, v1
    v_lshl_add_u32 v4, v5, 4, v4
    v_bfe_u32 v5, v1, 1, 1
    v_lshl_add_u32 v4, v5, 3, v4
    s_mul_i32 s19, s22, 32832
    v_xor_b32 v6, s19, v4
    v_xor_b32 v7, 64, v6
    s_lshl_b32 s19, s16, 12
    s_add_u32 s19, s19, 65536
    v_add_u32 v8, s19, v2
    s_xor_b32 s19, s19, 8192
    v_add_u32 v9, s19, v2
    v_and_b32 v4, 15, v1
    v_lshlrev_b32 v4, 11, v4
    v_lshrrev_b32 v5, 5, v1
    v_lshl_add_u32 v10, v5, 4, v4
    v_and_b32 v4, 16, v1
    v_lshl_add_u32 v10, v4, 1, v10
    s_lshl_b32 s23, s17, 16
    s_lshl_b32 s19, s18, 7
    s_add_u32 s23, s23, s19
    s_lshl_b32 s19, s22, 6
    s_add_u32 s23, s23, s19
    s_waitcnt vmcnt(26)
    s_barrier
    ds_read_b64_tr_b16 v[108:109], v6 offset:0
    ds_read_b64_tr_b16 v[110:111], v6 offset:512
    ds_read_b64_tr_b16 v[112:113], v7 offset:0
    ds_read_b64_tr_b16 v[114:115], v7 offset:512
    ds_read_b64_tr_b16 v[116:117], v6 offset:2048
    ds_read_b64_tr_b16 v[118:119], v6 offset:2560
    ds_read_b64_tr_b16 v[120:121], v7 offset:2048
    ds_read_b64_tr_b16 v[122:123], v7 offset:2560
    ds_read_b64_tr_b16 v[124:125], v6 offset:4096
    ds_read_b64_tr_b16 v[126:127], v6 offset:4608
    ds_read_b64_tr_b16 v[128:129], v7 offset:4096
    ds_read_b64_tr_b16 v[130:131], v7 offset:4608
    ds_read_b64_tr_b16 v[132:133], v6 offset:6144
    ds_read_b64_tr_b16 v[134:135], v6 offset:6656
    ds_read_b64_tr_b16 v[136:137], v7 offset:6144
    ds_read_b64_tr_b16 v[138:139], v7 offset:6656
    s_waitcnt lgkmcnt(0) vmcnt(18)
    s_barrier
    ds_read_b64_tr_b16 v[140:141], v6 offset:8192
    v_mfma_f32_32x32x16_bf16 v[28:43], v[112:115], v[44:47], 0
    ds_read_b64_tr_b16 v[142:143], v6 offset:8704
    ds_read_b64_tr_b16 v[144:145], v7 offset:8192
    v_mfma_f32_32x32x16_bf16 v[12:27], v[108:111], v[44:47], 0
    ds_read_b64_tr_b16 v[146:147], v7 offset:8704
    ds_read_b64_tr_b16 v[148:149], v6 offset:10240
    v_mfma_f32_32x32x16_bf16 v[28:43], v[120:123], v[48:51], v[28:43]
    ds_read_b64_tr_b16 v[150:151], v6 offset:10752
    ds_read_b64_tr_b16 v[152:153], v7 offset:10240
    v_mfma_f32_32x32x16_bf16 v[12:27], v[116:119], v[48:51], v[12:27]
    ds_read_b64_tr_b16 v[154:155], v7 offset:10752
    ds_read_b64_tr_b16 v[156:157], v6 offset:12288
    v_mfma_f32_32x32x16_bf16 v[28:43], v[128:131], v[52:55], v[28:43]
    ds_read_b64_tr_b16 v[158:159], v6 offset:12800
    ds_read_b64_tr_b16 v[160:161], v7 offset:12288
    v_mfma_f32_32x32x16_bf16 v[12:27], v[124:127], v[52:55], v[12:27]
    ds_read_b64_tr_b16 v[162:163], v7 offset:12800
    ds_read_b64_tr_b16 v[164:165], v6 offset:14336
    v_mfma_f32_32x32x16_bf16 v[28:43], v[136:139], v[56:59], v[28:43]
    ds_read_b64_tr_b16 v[166:167], v6 offset:14848
    ds_read_b64_tr_b16 v[168:169], v7 offset:14336
    v_mfma_f32_32x32x16_bf16 v[12:27], v[132:135], v[56:59], v[12:27]
    ds_read_b64_tr_b16 v[170:171], v7 offset:14848
    s_waitcnt lgkmcnt(0) vmcnt(10)
    s_barrier
    ds_read_b64_tr_b16 v[108:109], v6 offset:16384
    v_mfma_f32_32x32x16_bf16 v[28:43], v[144:147], v[60:63], v[28:43]
    ds_read_b64_tr_b16 v[110:111], v6 offset:16896
    ds_read_b64_tr_b16 v[112:113], v7 offset:16384
    v_mfma_f32_32x32x16_bf16 v[12:27], v[140:143], v[60:63], v[12:27]
    ds_read_b64_tr_b16 v[114:115], v7 offset:16896
    ds_read_b64_tr_b16 v[116:117], v6 offset:18432
    v_mfma_f32_32x32x16_bf16 v[28:43], v[152:155], v[64:67], v[28:43]
    ds_read_b64_tr_b16 v[118:119], v6 offset:18944
    ds_read_b64_tr_b16 v[120:121], v7 offset:18432
    v_mfma_f32_32x32x16_bf16 v[12:27], v[148:151], v[64:67], v[12:27]
    ds_read_b64_tr_b16 v[122:123], v7 offset:18944
    ds_read_b64_tr_b16 v[124:125], v6 offset:20480
    v_mfma_f32_32x32x16_bf16 v[28:43], v[160:163], v[68:71], v[28:43]
    ds_read_b64_tr_b16 v[126:127], v6 offset:20992
    ds_read_b64_tr_b16 v[128:129], v7 offset:20480
    v_mfma_f32_32x32x16_bf16 v[12:27], v[156:159], v[68:71], v[12:27]
    ds_read_b64_tr_b16 v[130:131], v7 offset:20992
    ds_read_b64_tr_b16 v[132:133], v6 offset:22528
    v_mfma_f32_32x32x16_bf16 v[28:43], v[168:171], v[72:75], v[28:43]
    ds_read_b64_tr_b16 v[134:135], v6 offset:23040
    ds_read_b64_tr_b16 v[136:137], v7 offset:22528
    v_mfma_f32_32x32x16_bf16 v[12:27], v[164:167], v[72:75], v[12:27]
    ds_read_b64_tr_b16 v[138:139], v7 offset:23040
    s_waitcnt lgkmcnt(0) vmcnt(2)
    s_barrier
    ds_read_b64_tr_b16 v[140:141], v6 offset:24576
    v_mfma_f32_32x32x16_bf16 v[28:43], v[112:115], v[76:79], v[28:43]
    ds_read_b64_tr_b16 v[142:143], v6 offset:25088
    ds_read_b64_tr_b16 v[144:145], v7 offset:24576
    v_mfma_f32_32x32x16_bf16 v[12:27], v[108:111], v[76:79], v[12:27]
    ds_read_b64_tr_b16 v[146:147], v7 offset:25088
    ds_read_b64_tr_b16 v[148:149], v6 offset:26624
    v_mfma_f32_32x32x16_bf16 v[28:43], v[120:123], v[80:83], v[28:43]
    ds_read_b64_tr_b16 v[150:151], v6 offset:27136
    ds_read_b64_tr_b16 v[152:153], v7 offset:26624
    v_mfma_f32_32x32x16_bf16 v[12:27], v[116:119], v[80:83], v[12:27]
    ds_read_b64_tr_b16 v[154:155], v7 offset:27136
    ds_read_b64_tr_b16 v[156:157], v6 offset:28672
    v_mfma_f32_32x32x16_bf16 v[28:43], v[128:131], v[84:87], v[28:43]
    ds_read_b64_tr_b16 v[158:159], v6 offset:29184
    ds_read_b64_tr_b16 v[160:161], v7 offset:28672
    v_mfma_f32_32x32x16_bf16 v[12:27], v[124:127], v[84:87], v[12:27]
    ds_read_b64_tr_b16 v[162:163], v7 offset:29184
    ds_read_b64_tr_b16 v[164:165], v6 offset:30720
    v_mfma_f32_32x32x16_bf16 v[28:43], v[136:139], v[88:91], v[28:43]
    ds_read_b64_tr_b16 v[166:167], v6 offset:31232
    ds_read_b64_tr_b16 v[168:169], v7 offset:30720
    v_mfma_f32_32x32x16_bf16 v[12:27], v[132:135], v[88:91], v[12:27]
    ds_read_b64_tr_b16 v[170:171], v7 offset:31232
    s_waitcnt lgkmcnt(0) vmcnt(0)
    v_mfma_f32_32x32x16_bf16 v[28:43], v[144:147], v[92:95], v[28:43]
    buffer_store_dword v172, v181, s[12:15], s28 offen offset:0 sc1
    v_mfma_f32_32x32x16_bf16 v[12:27], v[140:143], v[92:95], v[12:27]
    buffer_store_dword v173, v181, s[12:15], s28 offen offset:2048 sc1
    v_mfma_f32_32x32x16_bf16 v[28:43], v[152:155], v[96:99], v[28:43]
    buffer_store_dword v174, v181, s[12:15], s29 offen offset:0 sc1
    v_mfma_f32_32x32x16_bf16 v[12:27], v[148:151], v[96:99], v[12:27]
    buffer_store_dword v175, v181, s[12:15], s29 offen offset:2048 sc1
    v_mfma_f32_32x32x16_bf16 v[28:43], v[160:163], v[100:103], v[28:43]
    buffer_store_dword v176, v181, s[12:15], s30 offen offset:0 sc1
    v_mfma_f32_32x32x16_bf16 v[12:27], v[156:159], v[100:103], v[12:27]
    buffer_store_dword v177, v181, s[12:15], s30 offen offset:2048 sc1
    v_mfma_f32_32x32x16_bf16 v[28:43], v[168:171], v[104:107], v[28:43]
    buffer_store_dword v178, v181, s[12:15], s31 offen offset:0 sc1
    v_mfma_f32_32x32x16_bf16 v[12:27], v[164:167], v[104:107], v[12:27]
    buffer_store_dword v179, v181, s[12:15], s31 offen offset:2048 sc1
    s_nop 8
    ds_write_b128 v8, v[28:31] offset:0
    ds_write_b128 v8, v[32:35] offset:1024
    ds_write_b128 v8, v[36:39] offset:2048
    ds_write_b128 v8, v[40:43] offset:3072
    s_waitcnt lgkmcnt(0)
    s_barrier
    ds_read_b128 v[28:31], v9 offset:0
    ds_read_b128 v[32:35], v9 offset:1024
    ds_read_b128 v[36:39], v9 offset:2048
    ds_read_b128 v[40:43], v9 offset:3072
    s_waitcnt lgkmcnt(0)
    v_pk_add_f32 v[12:13], v[12:13], v[28:29]
    v_pk_add_f32 v[14:15], v[14:15], v[30:31]
    v_pk_add_f32 v[16:17], v[16:17], v[32:33]
    v_pk_add_f32 v[18:19], v[18:19], v[34:35]
    v_pk_add_f32 v[20:21], v[20:21], v[36:37]
    v_pk_add_f32 v[22:23], v[22:23], v[38:39]
    v_pk_add_f32 v[24:25], v[24:25], v[40:41]
    v_pk_add_f32 v[26:27], v[26:27], v[42:43]
    v_cvt_pk_bf16_f32 v44, v12, v13
    v_cvt_pk_bf16_f32 v48, v20, v21
    v_cvt_pk_bf16_f32 v45, v14, v15
    v_cvt_pk_bf16_f32 v49, v22, v23
    v_cvt_pk_bf16_f32 v46, v16, v17
    v_cvt_pk_bf16_f32 v50, v24, v25
    v_cvt_pk_bf16_f32 v47, v18, v19
    v_cvt_pk_bf16_f32 v51, v26, v27
    s_add_u32 s19, s23, 32768
    v_permlane16_swap_b32 v44, v48
    v_permlane16_swap_b32 v45, v49
    v_permlane16_swap_b32 v46, v50
    v_permlane16_swap_b32 v47, v51
    buffer_store_dwordx4 v[44:47], v10, s[12:15], s23 offen offset:1024 sc1
    buffer_store_dwordx4 v[48:51], v10, s[12:15], s19 offen offset:1024 sc1
L_k3_end:
    s_endpgm
.section .rodata,"a"
.p2align 6
.amdhsa_kernel qkv_kgen_kernel
  .amdhsa_next_free_vgpr 184
  .amdhsa_next_free_sgpr 102
  .amdhsa_accum_offset 184
  .amdhsa_group_segment_fixed_size 0
  .amdhsa_kernarg_size 120
  .amdhsa_user_sgpr_count 2
  .amdhsa_user_sgpr_kernarg_segment_ptr 1
  .amdhsa_system_sgpr_workgroup_id_x 1
.end_amdhsa_kernel
.p2align 6
.amdhsa_kernel attn_conv_kernel
  .amdhsa_next_free_vgpr 112
  .amdhsa_next_free_sgpr 102
  .amdhsa_accum_offset 112
  .amdhsa_group_segment_fixed_size 0
  .amdhsa_kernarg_size 120
  .amdhsa_user_sgpr_count 2
  .amdhsa_user_sgpr_kernarg_segment_ptr 1
  .amdhsa_system_sgpr_workgroup_id_x 1
.end_amdhsa_kernel
.p2align 6
.amdhsa_kernel concat_heads__ssm_conv_s4__mha_block__prompt_kernel
  .amdhsa_next_free_vgpr 184
  .amdhsa_next_free_sgpr 102
  .amdhsa_accum_offset 184
  .amdhsa_group_segment_fixed_size 0
  .amdhsa_kernarg_size 120
  .amdhsa_user_sgpr_count 2
  .amdhsa_user_sgpr_kernarg_segment_ptr 1
  .amdhsa_system_sgpr_workgroup_id_x 1
.end_amdhsa_kernel
```
